```python
import torch

def _softmax(x, axis=-1):
    return torch.softmax(x, dim=axis)
def _gelu(x):
    return torch.nn.functional.gelu(x, approximate="tanh")
def _silu(x):
    return torch.nn.functional.silu(x)
def _sigmoid(x):
    return torch.sigmoid(x)
def _layernorm(x, axis=-1, eps=1e-5):
    m = x.mean(dim=axis, keepdim=True)
    v = x.var(dim=axis, keepdim=True, unbiased=False)
    return (x - m) / torch.sqrt(v + eps)
def _scatter_add(tgt, idx, src, axis=0):
    return tgt.clone().index_add_(axis, idx, src)
def _segment_sum(src, seg, n):
    out = torch.zeros((n,) + src.shape[1:], dtype=src.dtype)
    return out.index_add_(0, seg, src)
def _pad(x, pw):
    flat = tuple(v for pair in reversed(pw) for v in pair)
    return torch.nn.functional.pad(x, flat)

kernel_name = 'concat_heads__gqa_block_cached__mha_block_cached__near_ridge'

def setup_inputs():

    _w = (lambda a: (lambda t: t.to(torch.bfloat16) if t.is_floating_point() else t)(torch.as_tensor(a)))
    def _A_setup():
        B, Sq, D = 16, 32, 1024
        Hq, Hkv, Sk, Dh = 32, 4, 32, 128
        assert Hq % Hkv == 0, (Hq, Hkv)
        return {
            "x": _w((lambda *s: torch.randn(*s, dtype=torch.bfloat16) * 0.8)(B, Sq, D)),
            "k_cache": _w((lambda *s: torch.randn(*s, dtype=torch.bfloat16) * 0.8)(B, Hkv, Sk, Dh)),
            "v_cache": _w((lambda *s: torch.randn(*s, dtype=torch.bfloat16) * 0.05)(B, Hkv, Sk, Dh)),
            "wq": _w((lambda *s: torch.randn(*s, dtype=torch.bfloat16) * 0.8)(D, Hq * Dh) * (D ** -0.5)),
            "wo": _w((lambda *s: torch.randn(*s, dtype=torch.bfloat16) * 0.05)(Hq * Dh, D) * ((Hq * Dh) ** -0.5)),
        }
    _A_in = _A_setup()

    def _B_setup():
        B, Sq, D = 16, 32, 1024
        H, Sk, Dh = 32, 32, 128
        return {
            "x": _w((lambda *s: torch.randn(*s, dtype=torch.bfloat16) * 0.8)(B, Sq, D)),
            "k_cache": _w((lambda *s: torch.randn(*s, dtype=torch.bfloat16) * 0.8)(B, H, Sk, Dh)),
            "v_cache": _w((lambda *s: torch.randn(*s, dtype=torch.bfloat16) * 0.05)(B, H, Sk, Dh)),
            "wq": _w((lambda *s: torch.randn(*s, dtype=torch.bfloat16) * 0.8)(D, H * Dh) * (D ** -0.5)),
            "wo": _w((lambda *s: torch.randn(*s, dtype=torch.bfloat16) * 0.05)(H * Dh, D) * ((H * Dh) ** -0.5)),
        }
    _B_in = _B_setup()

    return {
        "A_x": _A_in["x"],
        "A_k_cache": _A_in["k_cache"],
        "A_v_cache": _A_in["v_cache"],
        "A_wq": _A_in["wq"],
        "A_wo": _A_in["wo"],
        "B_x": _B_in["x"],
        "B_k_cache": _B_in["k_cache"],
        "B_v_cache": _B_in["v_cache"],
        "B_wq": _B_in["wq"],
        "B_wo": _B_in["wo"],
    }

def reference(A_x, A_k_cache, A_v_cache, A_wq, A_wo, B_x, B_k_cache, B_v_cache, B_wq, B_wo):
    def _A_ref(x, k_cache, v_cache, wq, wo):
        B, Sq, D = x.shape
        Hq, Dh = 32, 128
        Hkv = k_cache.shape[1]
        rep = Hq // Hkv
        q = (lambda x, *d: x.permute(*d))((x @ wq).reshape(B, Sq, Hq, Dh), 0, 2, 1, 3)
        k = (lambda x, n, axis: torch.repeat_interleave(x, n, dim=axis))(k_cache, rep, axis=1)
        v = (lambda x, n, axis: torch.repeat_interleave(x, n, dim=axis))(v_cache, rep, axis=1)
        scores = torch.einsum("bhqd,bhkd->bhqk", q, k) * (Dh ** -0.5)
        p = _softmax(scores, axis=-1)
        o = torch.einsum("bhqk,bhkd->bhqd", p, v)
        return (lambda x, *d: x.permute(*d))(o, 0, 2, 1, 3).reshape(B, Sq, Hq * Dh) @ wo

    def _B_ref(x, k_cache, v_cache, wq, wo):
        B, Sq, D = x.shape
        H, Dh = 32, 128
        q = (lambda x, *d: x.permute(*d))((x @ wq).reshape(B, Sq, H, Dh), 0, 2, 1, 3)
        scores = torch.einsum("bhqd,bhkd->bhqk", q, k_cache) * (Dh ** -0.5)
        p = _softmax(scores, axis=-1)
        o = torch.einsum("bhqk,bhkd->bhqd", p, v_cache)
        return (lambda x, *d: x.permute(*d))(o, 0, 2, 1, 3).reshape(B, Sq, H * Dh) @ wo

    a = _A_ref(A_x, A_k_cache, A_v_cache, A_wq, A_wo)
    b = _B_ref(B_x, B_k_cache, B_v_cache, B_wq, B_wo)
    return torch.concatenate([a, b], axis=-1)
```

```asm
; @launch grid=(256,1,1) block=(256,1,1) lds=163840
.amdgcn_target "amdgcn-amd-amdhsa--gfx950"
.text
.globl concat_heads__gqa_block_cached__mha_block_cached__near_ridge_kernel
.p2align 8
.type concat_heads__gqa_block_cached__mha_block_cached__near_ridge_kernel,@function
concat_heads__gqa_block_cached__mha_block_cached__near_ridge_kernel:
    s_cmp_ge_u32 s2, 256
    s_cbranch_scc1 L_end
    s_load_dwordx16 s[4:19], s[0:1], 0
    s_load_dwordx8 s[20:27], s[0:1], 64
    s_load_dwordx2 s[28:29], s[0:1], 96
    s_getpc_b64 s[44:45]
L_pc:
    s_lshr_b32 s39, s2, 3
    s_and_b32 s39, s39, 7
    s_lshl_b32 s39, s39, 12
    s_and_b32 s45, s45, 0xffff
    s_mov_b32 s46, L_end-L_pc
    s_mov_b32 s47, 0x20000
    v_lshl_add_u32 v1, v0, 4, s39
    buffer_load_dwordx4 v[176:179], v1, s[44:47], 0 offen
    s_and_b32 s30, s2, 7
    s_xor_b32 s30, s30, 4
    s_lshr_b32 s31, s2, 3
    s_lshr_b32 s32, s30, 2
    s_and_b32 s33, s30, 3
    s_lshr_b32 s34, s31, 3
    s_and_b32 s35, s31, 7
    v_lshrrev_b32 v1, 6, v0
    v_and_b32 v0, 63, v0
    s_lshl_b32 s37, s33, 3
    v_readfirstlane_b32 s36, v1
    s_add_u32 s37, s37, s35
    s_lshl_b32 s38, s34, 2
    v_lshrrev_b32 v2, 4, v0
    v_and_b32 v3, 15, v0
    s_add_u32 s38, s38, s36
    v_lshlrev_b32 v4, 2, v2
    v_xor_b32 v4, v4, v3
    v_lshlrev_b32 v4, 4, v4
    s_lshl_b32 s39, s36, 17
    s_lshl_b32 s40, s37, 8
    s_add_u32 s39, s39, s40
    v_lshl_add_u32 v5, v2, 13, v4
    v_add_u32 v10, s39, v5
    v_add_u32 v11, 31744, v10
    v_add_u32 v12, 63488, v10
    v_add_u32 v13, 95232, v10
    v_xor_b32 v12, 32, v12
    v_xor_b32 v13, 32, v13
    v_lshrrev_b32 v5, 3, v0
    v_and_b32 v6, 7, v0
    v_xor_b32 v6, v6, v2
    v_lshlrev_b32 v6, 4, v6
    v_lshl_add_u32 v5, v5, 11, v6
    s_lshl_b32 s39, s38, 16
    v_add_u32 v14, s39, v5
    v_xor_b32 v5, 64, v14
    v_add_u32 v15, 15360, v5
    v_add_u32 v16, 30720, v14
    v_add_u32 v17, 46080, v5
    s_waitcnt lgkmcnt(0)
    s_cmp_eq_u32 s32, 0
    s_cselect_b64 s[4:5], s[4:5], s[14:15]
    s_cselect_b64 s[6:7], s[6:7], s[16:17]
    s_cselect_b64 s[8:9], s[8:9], s[18:19]
    s_cselect_b64 s[10:11], s[10:11], s[20:21]
    s_cselect_b64 s[12:13], s[12:13], s[22:23]
    s_cselect_b32 s41, 1, 8
    s_lshl_b32 s41, s41, 19
    s_mov_b32 s44, s4
    s_and_b32 s45, s5, 0xffff
    s_mov_b32 s46, 0x100000
    s_mov_b32 s47, 0x20000
    s_mov_b32 s48, s10
    s_and_b32 s49, s11, 0xffff
    s_mov_b32 s50, 0x800000
    s_mov_b32 s51, 0x20000
    s_mov_b32 s64, s28
    s_and_b32 s65, s29, 0xffff
    s_mov_b32 s66, 0x10000000
    s_mov_b32 s67, 0x20000
    s_mul_i32 s28, s35, 0
    s_mul_i32 s39, s34, 4
    s_add_u32 s28, s28, s39
    s_mul_i32 s39, s33, 4
    s_add_u32 s28, s28, s39
    s_lshl_b32 s43, s36, 12
    s_lshl_b32 s68, s36, 13
    s_or_b32 s39, s31, s36
    s_cmp_eq_u32 s39, 0
    s_cselect_b32 s42, 0, 0x7fff0000
    v_lshrrev_b32 v5, 1, v0
    v_and_b32 v6, 1, v0
    v_lshlrev_b32 v6, 4, v6
    v_lshl_add_u32 v5, v5, 7, v6
    v_add_u32 v5, s42, v5
    s_lshl_b32 s14, s30, 12
    s_add_u32 s14, s14, 50331648
    v_mov_b32 v168, 0
    v_mov_b32 v169, 0
    v_mov_b32 v170, 0
    v_mov_b32 v171, 0
    buffer_store_dwordx4 v[168:171], v5, s[64:67], s14 offen sc1
    s_add_u32 s39, s28, 0
    s_and_b32 s39, s39, 15
    s_add_u32 m0, s43, 0
    s_lshl_b32 s40, s39, 19
    buffer_load_dwordx4 v10, s[48:51], s40 offen offset:0  lds
    buffer_load_dwordx4 v11, s[48:51], s40 offen offset:1024  lds
    buffer_load_dwordx4 v12, s[48:51], s40 offen offset:2048  lds
    buffer_load_dwordx4 v13, s[48:51], s40 offen offset:3072  lds
    s_add_u32 m0, s43, 16384
    s_lshl_b32 s40, s39, 7
    buffer_load_dwordx4 v14, s[44:47], s40 offen offset:0  lds
    buffer_load_dwordx4 v15, s[44:47], s40 offen offset:1024  lds
    buffer_load_dwordx4 v16, s[44:47], s40 offen offset:2048  lds
    buffer_load_dwordx4 v17, s[44:47], s40 offen offset:3072  lds
    s_add_u32 s39, s28, 1
    s_and_b32 s39, s39, 15
    s_add_u32 m0, s43, 32768
    s_lshl_b32 s40, s39, 19
    buffer_load_dwordx4 v10, s[48:51], s40 offen offset:0  lds
    buffer_load_dwordx4 v11, s[48:51], s40 offen offset:1024  lds
    buffer_load_dwordx4 v12, s[48:51], s40 offen offset:2048  lds
    buffer_load_dwordx4 v13, s[48:51], s40 offen offset:3072  lds
    s_add_u32 m0, s43, 49152
    s_lshl_b32 s40, s39, 7
    buffer_load_dwordx4 v14, s[44:47], s40 offen offset:0  lds
    buffer_load_dwordx4 v15, s[44:47], s40 offen offset:1024  lds
    buffer_load_dwordx4 v16, s[44:47], s40 offen offset:2048  lds
    buffer_load_dwordx4 v17, s[44:47], s40 offen offset:3072  lds
    s_add_u32 s39, s28, 2
    s_and_b32 s39, s39, 15
    s_add_u32 m0, s43, 65536
    s_lshl_b32 s40, s39, 19
    buffer_load_dwordx4 v10, s[48:51], s40 offen offset:0  lds
    buffer_load_dwordx4 v11, s[48:51], s40 offen offset:1024  lds
    buffer_load_dwordx4 v12, s[48:51], s40 offen offset:2048  lds
    buffer_load_dwordx4 v13, s[48:51], s40 offen offset:3072  lds
    s_add_u32 m0, s43, 81920
    s_lshl_b32 s40, s39, 7
    buffer_load_dwordx4 v14, s[44:47], s40 offen offset:0  lds
    buffer_load_dwordx4 v15, s[44:47], s40 offen offset:1024  lds
    buffer_load_dwordx4 v16, s[44:47], s40 offen offset:2048  lds
    buffer_load_dwordx4 v17, s[44:47], s40 offen offset:3072  lds
    s_mov_b32 s52, s6
    s_and_b32 s53, s7, 0xffff
    s_mov_b32 s54, 0x0
    s_mov_b32 s55, 0x20000
    s_mov_b32 s54, s41
    s_mov_b32 s56, s8
    s_and_b32 s57, s9, 0xffff
    s_mov_b32 s58, 0x0
    s_mov_b32 s59, 0x20000
    s_mov_b32 s58, s41
    s_mov_b32 s60, s12
    s_and_b32 s61, s13, 0xffff
    s_mov_b32 s62, 0x800000
    s_mov_b32 s63, 0x20000
    s_mov_b32 s16, s26
    s_and_b32 s17, s27, 0xffff
    s_mov_b32 s18, 0x100
    s_mov_b32 s19, 0x20000
    s_mov_b32 s20, s24
    s_and_b32 s21, s25, 0xffff
    s_mov_b32 s22, 0x200000
    s_mov_b32 s23, 0x20000
    s_lshl_b32 s39, s38, 5
    s_add_u32 s39, s39, s37
    s_lshl_b32 s40, s38, 2
    s_add_u32 s40, s40, s33
    s_cmp_eq_u32 s32, 0
    s_cselect_b32 s31, s40, s39
    s_lshl_b32 s31, s31, 13
    v_lshl_add_u32 v26, v2, 8, v4
    v_add_u32 v5, 0, v2
    v_xor_b32 v5, v5, v3
    v_lshlrev_b32 v5, 4, v5
    v_lshl_add_u32 v22, v2, 8, v5
    v_add_u32 v5, 4, v2
    v_xor_b32 v5, v5, v3
    v_lshlrev_b32 v5, 4, v5
    v_lshl_add_u32 v23, v2, 8, v5
    v_add_u32 v5, 8, v2
    v_xor_b32 v5, v5, v3
    v_lshlrev_b32 v5, 4, v5
    v_lshl_add_u32 v24, v2, 8, v5
    v_add_u32 v5, 12, v2
    v_xor_b32 v5, v5, v3
    v_lshlrev_b32 v5, 4, v5
    v_lshl_add_u32 v25, v2, 8, v5
    s_lshl_b32 s39, s33, 21
    s_lshl_b32 s40, s36, 16
    s_add_u32 s39, s39, s40
    s_lshl_b32 s40, s35, 8
    s_add_u32 s39, s39, s40
    v_lshl_add_u32 v5, v2, 11, v4
    v_add_u32 v18, s39, v5
    v_add_u32 v19, 7168, v18
    v_add_u32 v20, 14336, v18
    v_add_u32 v21, 21504, v18
    v_lshrrev_b32 v5, 2, v3
    v_lshrrev_b32 v6, 5, v0
    v_and_b32 v1, 1, v2
    v_lshlrev_b32 v1, 5, v1
    v_and_b32 v7, 1, v0
    v_lshl_add_u32 v1, v7, 4, v1
    v_bfe_u32 v7, v0, 1, 1
    v_lshl_add_u32 v1, v7, 3, v1
    v_lshl_add_u32 v1, v5, 8, v1
    v_lshl_add_u32 v1, v5, 6, v1
    v_lshl_add_u32 v27, v6, 10, v1
    v_lshl_add_u32 v1, v6, 11, v1
    v_lshrrev_b32 v5, 2, v3
    v_and_b32 v7, 3, v0
    v_lshlrev_b32 v1, 3, v7
    v_lshl_add_u32 v1, v5, 8, v1
    v_lshl_add_u32 v1, v5, 6, v1
    v_lshl_add_u32 v1, v6, 12, v1
    v_and_b32 v7, 1, v2
    v_lshl_add_u32 v1, v7, 5, v1
    v_lshl_add_u32 v1, v7, 11, v1
    v_xor_b32 v5, 0, v1
    v_add_u32 v52, 0, v5
    v_add_u32 v56, 65536, v5
    v_add_u32 v60, 131072, v5
    v_xor_b32 v5, 32, v1
    v_add_u32 v28, 0, v5
    v_add_u32 v32, 65536, v5
    v_add_u32 v36, 131072, v5
    v_xor_b32 v5, 64, v1
    v_add_u32 v53, 0, v5
    v_add_u32 v57, 65536, v5
    v_add_u32 v61, 131072, v5
    v_xor_b32 v5, 96, v1
    v_add_u32 v29, 0, v5
    v_add_u32 v33, 65536, v5
    v_add_u32 v37, 131072, v5
    v_xor_b32 v5, 128, v1
    v_add_u32 v54, 0, v5
    v_add_u32 v58, 65536, v5
    v_add_u32 v62, 131072, v5
    v_xor_b32 v5, 160, v1
    v_add_u32 v30, 0, v5
    v_add_u32 v34, 65536, v5
    v_add_u32 v38, 131072, v5
    v_xor_b32 v5, 192, v1
    v_add_u32 v55, 0, v5
    v_add_u32 v59, 65536, v5
    v_add_u32 v63, 131072, v5
    v_xor_b32 v5, 224, v1
    v_add_u32 v31, 0, v5
    v_add_u32 v35, 65536, v5
    v_add_u32 v39, 131072, v5
    v_mov_b32 v5, v3
    v_bfe_u32 v7, v0, 1, 3
    v_xor_b32 v7, v7, v2
    v_lshlrev_b32 v7, 4, v7
    v_lshl_add_u32 v7, v5, 7, v7
    s_add_u32 s39, s43, 16384
    v_add_u32 v7, s39, v7
    v_xor_b32 v5, 0, v7
    v_add_u32 v40, 0, v5
    v_xor_b32 v5, 64, v7
    v_add_u32 v42, 0, v5
    v_xor_b32 v5, 0, v7
    v_add_u32 v44, 65536, v5
    v_xor_b32 v5, 64, v7
    v_add_u32 v46, 65536, v5
    v_xor_b32 v5, 0, v7
    v_add_u32 v48, 131072, v5
    v_xor_b32 v5, 64, v7
    v_add_u32 v50, 131072, v5
    s_lshl_b32 s39, s30, 4
    s_add_u32 s39, s39, s38
    s_lshl_b32 s69, s39, 16
    s_lshl_b32 s39, s32, 4
    s_add_u32 s39, s39, s38
    s_lshl_b32 s39, s39, 3
    s_add_u32 s39, s39, s35
    s_mul_i32 s3, s39, 24576
    s_add_u32 s3, s3, 16777216
    s_mul_i32 s4, s33, 6144
    s_add_u32 s4, s4, s3
    s_add_u32 s5, s4, 4096
    s_getreg_b32 s15, hwreg(HW_REG_XCC_ID, 0, 4)
    s_add_u32 s15, s15, 1
    s_add_u32 s39, s34, 16
    s_lshl_b32 s39, s39, 7
    s_add_u32 s6, s14, s39
    s_lshl_b32 s39, s32, 2
    s_add_u32 s39, s39, s34
    s_lshl_b32 s39, s39, 5
    s_add_u32 s39, s39, s35
    s_add_u32 s39, s39, 20
    s_lshl_b32 s39, s39, 7
    s_add_u32 s7, s39, 50331648
    s_lshl_b32 s39, s38, 7
    s_add_u32 s14, s14, s39
    v_lshlrev_b32 v1, 4, v0
    v_mov_b32 v5, 0x7fff0000
    v_cmp_eq_u32 vcc, 0, v0
    s_lshl_b32 s8, s35, 2
    v_mov_b32 v6, s8
    s_lshl_b32 s39, s30, 2
    s_add_u32 s39, s39, s42
    v_cndmask_b32 v8, v5, v6, vcc
    v_mov_b32 v6, s39
    v_cndmask_b32 v200, v5, v6, vcc
    s_cmp_eq_u32 s36, 0
    s_cselect_b32 s42, 0, 0x7fff0000
    s_add_u32 s8, s8, s6
    s_or_b32 s8, s8, s42
    v_mov_b32 v6, s8
    v_cndmask_b32 v202, v5, v6, vcc
    s_lshl_b32 s8, s33, 2
    s_add_u32 s8, s8, s7
    s_or_b32 s8, s8, s42
    v_cmp_eq_u32 vcc, 1, v0
    v_mov_b32 v6, s8
    v_and_b32 v5, 3, v0
    v_cndmask_b32 v202, v202, v6, vcc
    s_lshl_b32 s39, s32, 4
    s_add_u32 s39, s39, s42
    v_lshl_add_u32 v201, v5, 2, s39
    v_cmp_gt_u32 vcc, 8, v0
    v_lshl_add_u32 v5, v5, 2, s7
    v_lshl_add_u32 v6, v0, 2, s6
    v_cndmask_b32 v4, v5, v6, vcc
    v_mov_b32 v204, s15
    v_mov_b32 v172, -1
    v_mov_b32 v173, -1
    v_mov_b32 v174, -1
    v_mov_b32 v175, -1
    s_lshl_b32 s10, s35, 13
    s_add_u32 s10, s69, s10
    s_add_u32 s11, s10, 4096
    s_mov_b32 s29, 0x76543210
    s_cmp_eq_u32 s34, 1
    s_cselect_b32 s29, 0x21765430, s29
    s_cmp_eq_u32 s34, 2
    s_cselect_b32 s29, 0x43217650, s29
    s_cmp_eq_u32 s34, 3
    s_cselect_b32 s29, 0x65432170, s29
    s_mul_i32 s39, s35, 0x11111111
    s_add_u32 s29, s29, s39
    v_lshlrev_b32 v205, 7, v0
    v_lshrrev_b32 v5, 1, v0
    v_and_b32 v6, 1, v0
    v_lshlrev_b32 v6, 7, v6
    v_lshl_add_u32 v5, v5, 11, v6
    s_lshl_b32 s39, s33, 21
    s_lshl_b32 s40, s34, 19
    s_add_u32 s39, s39, s40
    s_lshl_b32 s40, s36, 17
    s_add_u32 s39, s39, s40
    s_lshl_b32 s40, s35, 8
    s_add_u32 s39, s39, s40
    v_add_u32 v206, s39, v5
    s_waitcnt vmcnt(16)
    s_barrier
    buffer_store_dword v204, v200, s[16:19], 0 offen sc1
    ds_read_b128 v[160:163], v40 offset:0
    ds_read_b128 v[164:167], v40 offset:2048
    ds_read_b64_tr_b16 v[128:129], v52 offset:0
    ds_read_b64_tr_b16 v[130:131], v52 offset:1024
    ds_read_b64_tr_b16 v[132:133], v53 offset:0
    ds_read_b64_tr_b16 v[134:135], v53 offset:1024
    ds_read_b64_tr_b16 v[136:137], v54 offset:0
    ds_read_b64_tr_b16 v[138:139], v54 offset:1024
    ds_read_b64_tr_b16 v[140:141], v55 offset:0
    ds_read_b64_tr_b16 v[142:143], v55 offset:1024
    s_waitcnt lgkmcnt(6)
    v_mfma_f32_16x16x32_bf16 v[64:67], v[128:131], v[160:163], 0
    ds_read_b64_tr_b16 v[144:145], v28 offset:0
    ds_read_b64_tr_b16 v[146:147], v28 offset:1024
    v_mfma_f32_16x16x32_bf16 v[68:71], v[128:131], v[164:167], 0
    ds_read_b64_tr_b16 v[148:149], v29 offset:0
    s_add_u32 s39, s28, 3
    s_and_b32 s39, s39, 15
    s_add_u32 m0, s43, 98304
    s_lshl_b32 s40, s39, 19
    buffer_load_dwordx4 v10, s[48:51], s40 offen offset:0  lds
    s_waitcnt lgkmcnt(7)
    v_mfma_f32_16x16x32_bf16 v[80:83], v[132:135], v[160:163], 0
    ds_read_b64_tr_b16 v[150:151], v29 offset:1024
    ds_read_b64_tr_b16 v[152:153], v30 offset:0
    v_mfma_f32_16x16x32_bf16 v[84:87], v[132:135], v[164:167], 0
    buffer_load_dwordx4 v11, s[48:51], s40 offen offset:1024  lds
    s_waitcnt lgkmcnt(7)
    v_mfma_f32_16x16x32_bf16 v[96:99], v[136:139], v[160:163], 0
    ds_read_b64_tr_b16 v[154:155], v30 offset:1024
    ds_read_b64_tr_b16 v[156:157], v31 offset:0
    v_mfma_f32_16x16x32_bf16 v[100:103], v[136:139], v[164:167], 0
    ds_read_b64_tr_b16 v[158:159], v31 offset:1024
    buffer_load_dwordx4 v12, s[48:51], s40 offen offset:2048  lds
    s_waitcnt lgkmcnt(8)
    v_mfma_f32_16x16x32_bf16 v[112:115], v[140:143], v[160:163], 0
    v_mfma_f32_16x16x32_bf16 v[116:119], v[140:143], v[164:167], 0
    buffer_load_dwordx4 v13, s[48:51], s40 offen offset:3072  lds
    s_waitcnt lgkmcnt(6)
    v_mfma_f32_16x16x32_bf16 v[72:75], v[144:147], v[160:163], 0
    ds_read_b128 v[176:179], v42 offset:0
    ds_read_b128 v[180:183], v42 offset:2048
    v_mfma_f32_16x16x32_bf16 v[76:79], v[144:147], v[164:167], 0
    ds_read_b64_tr_b16 v[128:129], v52 offset:8192
    s_add_u32 m0, s43, 114688
    s_lshl_b32 s40, s39, 7
    buffer_load_dwordx4 v14, s[44:47], s40 offen offset:0  lds
    s_waitcnt lgkmcnt(7)
    v_mfma_f32_16x16x32_bf16 v[88:91], v[148:151], v[160:163], 0
    ds_read_b64_tr_b16 v[130:131], v52 offset:9216
    ds_read_b64_tr_b16 v[132:133], v53 offset:8192
    v_mfma_f32_16x16x32_bf16 v[92:95], v[148:151], v[164:167], 0
    buffer_load_dwordx4 v15, s[44:47], s40 offen offset:1024  lds
    s_waitcnt lgkmcnt(7)
    v_mfma_f32_16x16x32_bf16 v[104:107], v[152:155], v[160:163], 0
    ds_read_b64_tr_b16 v[134:135], v53 offset:9216
    ds_read_b64_tr_b16 v[136:137], v54 offset:8192
    v_mfma_f32_16x16x32_bf16 v[108:111], v[152:155], v[164:167], 0
    ds_read_b64_tr_b16 v[138:139], v54 offset:9216
    buffer_load_dwordx4 v16, s[44:47], s40 offen offset:2048  lds
    s_waitcnt lgkmcnt(8)
    v_mfma_f32_16x16x32_bf16 v[120:123], v[156:159], v[160:163], 0
    ds_read_b64_tr_b16 v[140:141], v55 offset:8192
    ds_read_b64_tr_b16 v[142:143], v55 offset:9216
    v_mfma_f32_16x16x32_bf16 v[124:127], v[156:159], v[164:167], 0
    buffer_load_dwordx4 v17, s[44:47], s40 offen offset:3072  lds
    s_waitcnt lgkmcnt(6)
    v_mfma_f32_16x16x32_bf16 v[64:67], v[128:131], v[176:179], v[64:67]
    ds_read_b64_tr_b16 v[144:145], v28 offset:8192
    ds_read_b64_tr_b16 v[146:147], v28 offset:9216
    v_mfma_f32_16x16x32_bf16 v[68:71], v[128:131], v[180:183], v[68:71]
    ds_read_b64_tr_b16 v[148:149], v29 offset:8192
    s_waitcnt lgkmcnt(7)
    v_mfma_f32_16x16x32_bf16 v[80:83], v[132:135], v[176:179], v[80:83]
    ds_read_b64_tr_b16 v[150:151], v29 offset:9216
    ds_read_b64_tr_b16 v[152:153], v30 offset:8192
    v_mfma_f32_16x16x32_bf16 v[84:87], v[132:135], v[180:183], v[84:87]
    s_add_u32 s39, s28, 4
    s_and_b32 s39, s39, 15
    s_add_u32 m0, s43, 131072
    s_lshl_b32 s40, s39, 19
    buffer_load_dwordx4 v10, s[48:51], s40 offen offset:0  lds
    s_waitcnt lgkmcnt(7)
    v_mfma_f32_16x16x32_bf16 v[96:99], v[136:139], v[176:179], v[96:99]
    ds_read_b64_tr_b16 v[154:155], v30 offset:9216
    ds_read_b64_tr_b16 v[156:157], v31 offset:8192
    v_mfma_f32_16x16x32_bf16 v[100:103], v[136:139], v[180:183], v[100:103]
    ds_read_b64_tr_b16 v[158:159], v31 offset:9216
    s_waitcnt lgkmcnt(8)
    v_mfma_f32_16x16x32_bf16 v[112:115], v[140:143], v[176:179], v[112:115]
    v_mfma_f32_16x16x32_bf16 v[116:119], v[140:143], v[180:183], v[116:119]
    buffer_load_dwordx4 v11, s[48:51], s40 offen offset:1024  lds
    s_waitcnt vmcnt(19) lgkmcnt(0)
    s_barrier
    v_mfma_f32_16x16x32_bf16 v[72:75], v[144:147], v[176:179], v[72:75]
    ds_read_b128 v[160:163], v40 offset:32768
    ds_read_b128 v[164:167], v40 offset:34816
    v_mfma_f32_16x16x32_bf16 v[76:79], v[144:147], v[180:183], v[76:79]
    ds_read_b64_tr_b16 v[128:129], v52 offset:32768
    buffer_load_dwordx4 v12, s[48:51], s40 offen offset:2048  lds
    v_mfma_f32_16x16x32_bf16 v[88:91], v[148:151], v[176:179], v[88:91]
    ds_read_b64_tr_b16 v[130:131], v52 offset:33792
    ds_read_b64_tr_b16 v[132:133], v53 offset:32768
    v_mfma_f32_16x16x32_bf16 v[92:95], v[148:151], v[180:183], v[92:95]
    buffer_load_dwordx4 v13, s[48:51], s40 offen offset:3072  lds
    v_mfma_f32_16x16x32_bf16 v[104:107], v[152:155], v[176:179], v[104:107]
    ds_read_b64_tr_b16 v[134:135], v53 offset:33792
    ds_read_b64_tr_b16 v[136:137], v54 offset:32768
    v_mfma_f32_16x16x32_bf16 v[108:111], v[152:155], v[180:183], v[108:111]
    ds_read_b64_tr_b16 v[138:139], v54 offset:33792
    s_add_u32 m0, s43, 147456
    s_lshl_b32 s40, s39, 7
    buffer_load_dwordx4 v14, s[44:47], s40 offen offset:0  lds
    v_mfma_f32_16x16x32_bf16 v[120:123], v[156:159], v[176:179], v[120:123]
    ds_read_b64_tr_b16 v[140:141], v55 offset:32768
    ds_read_b64_tr_b16 v[142:143], v55 offset:33792
    v_mfma_f32_16x16x32_bf16 v[124:127], v[156:159], v[180:183], v[124:127]
    buffer_load_dwordx4 v15, s[44:47], s40 offen offset:1024  lds
    s_waitcnt lgkmcnt(6)
    v_mfma_f32_16x16x32_bf16 v[64:67], v[128:131], v[160:163], v[64:67]
    ds_read_b64_tr_b16 v[144:145], v28 offset:32768
    ds_read_b64_tr_b16 v[146:147], v28 offset:33792
    v_mfma_f32_16x16x32_bf16 v[68:71], v[128:131], v[164:167], v[68:71]
    ds_read_b64_tr_b16 v[148:149], v29 offset:32768
    buffer_load_dwordx4 v16, s[44:47], s40 offen offset:2048  lds
    s_waitcnt lgkmcnt(7)
    v_mfma_f32_16x16x32_bf16 v[80:83], v[132:135], v[160:163], v[80:83]
    ds_read_b64_tr_b16 v[150:151], v29 offset:33792
    ds_read_b64_tr_b16 v[152:153], v30 offset:32768
    v_mfma_f32_16x16x32_bf16 v[84:87], v[132:135], v[164:167], v[84:87]
    buffer_load_dwordx4 v17, s[44:47], s40 offen offset:3072  lds
    s_waitcnt lgkmcnt(7)
    v_mfma_f32_16x16x32_bf16 v[96:99], v[136:139], v[160:163], v[96:99]
    ds_read_b64_tr_b16 v[154:155], v30 offset:33792
    ds_read_b64_tr_b16 v[156:157], v31 offset:32768
    v_mfma_f32_16x16x32_bf16 v[100:103], v[136:139], v[164:167], v[100:103]
    ds_read_b64_tr_b16 v[158:159], v31 offset:33792
    s_add_u32 s39, s28, 5
    s_and_b32 s39, s39, 15
    s_add_u32 m0, s43, 0
    s_lshl_b32 s40, s39, 19
    buffer_load_dwordx4 v10, s[48:51], s40 offen offset:0  lds
    s_waitcnt lgkmcnt(8)
    v_mfma_f32_16x16x32_bf16 v[112:115], v[140:143], v[160:163], v[112:115]
    v_mfma_f32_16x16x32_bf16 v[116:119], v[140:143], v[164:167], v[116:119]
    buffer_load_dwordx4 v11, s[48:51], s40 offen offset:1024  lds
    s_waitcnt lgkmcnt(6)
    v_mfma_f32_16x16x32_bf16 v[72:75], v[144:147], v[160:163], v[72:75]
    ds_read_b128 v[176:179], v42 offset:32768
    ds_read_b128 v[180:183], v42 offset:34816
    v_mfma_f32_16x16x32_bf16 v[76:79], v[144:147], v[164:167], v[76:79]
    ds_read_b64_tr_b16 v[128:129], v52 offset:40960
    s_waitcnt lgkmcnt(7)
    v_mfma_f32_16x16x32_bf16 v[88:91], v[148:151], v[160:163], v[88:91]
    ds_read_b64_tr_b16 v[130:131], v52 offset:41984
    ds_read_b64_tr_b16 v[132:133], v53 offset:40960
    v_mfma_f32_16x16x32_bf16 v[92:95], v[148:151], v[164:167], v[92:95]
    buffer_load_dwordx4 v12, s[48:51], s40 offen offset:2048  lds
    s_waitcnt lgkmcnt(7)
    v_mfma_f32_16x16x32_bf16 v[104:107], v[152:155], v[160:163], v[104:107]
    ds_read_b64_tr_b16 v[134:135], v53 offset:41984
    ds_read_b64_tr_b16 v[136:137], v54 offset:40960
    v_mfma_f32_16x16x32_bf16 v[108:111], v[152:155], v[164:167], v[108:111]
    ds_read_b64_tr_b16 v[138:139], v54 offset:41984
    s_waitcnt lgkmcnt(8)
    v_mfma_f32_16x16x32_bf16 v[120:123], v[156:159], v[160:163], v[120:123]
    ds_read_b64_tr_b16 v[140:141], v55 offset:40960
    ds_read_b64_tr_b16 v[142:143], v55 offset:41984
    v_mfma_f32_16x16x32_bf16 v[124:127], v[156:159], v[164:167], v[124:127]
    buffer_load_dwordx4 v13, s[48:51], s40 offen offset:3072  lds
    s_waitcnt lgkmcnt(6)
    v_mfma_f32_16x16x32_bf16 v[64:67], v[128:131], v[176:179], v[64:67]
    ds_read_b64_tr_b16 v[144:145], v28 offset:40960
    ds_read_b64_tr_b16 v[146:147], v28 offset:41984
    v_mfma_f32_16x16x32_bf16 v[68:71], v[128:131], v[180:183], v[68:71]
    ds_read_b64_tr_b16 v[148:149], v29 offset:40960
    s_waitcnt lgkmcnt(7)
    v_mfma_f32_16x16x32_bf16 v[80:83], v[132:135], v[176:179], v[80:83]
    ds_read_b64_tr_b16 v[150:151], v29 offset:41984
    ds_read_b64_tr_b16 v[152:153], v30 offset:40960
    v_mfma_f32_16x16x32_bf16 v[84:87], v[132:135], v[180:183], v[84:87]
    s_add_u32 m0, s43, 16384
    s_lshl_b32 s40, s39, 7
    buffer_load_dwordx4 v14, s[44:47], s40 offen offset:0  lds
    s_waitcnt lgkmcnt(7)
    v_mfma_f32_16x16x32_bf16 v[96:99], v[136:139], v[176:179], v[96:99]
    ds_read_b64_tr_b16 v[154:155], v30 offset:41984
    ds_read_b64_tr_b16 v[156:157], v31 offset:40960
    v_mfma_f32_16x16x32_bf16 v[100:103], v[136:139], v[180:183], v[100:103]
    ds_read_b64_tr_b16 v[158:159], v31 offset:41984
    s_waitcnt lgkmcnt(8)
    v_mfma_f32_16x16x32_bf16 v[112:115], v[140:143], v[176:179], v[112:115]
    v_mfma_f32_16x16x32_bf16 v[116:119], v[140:143], v[180:183], v[116:119]
    buffer_load_dwordx4 v15, s[44:47], s40 offen offset:1024  lds
    s_waitcnt vmcnt(23) lgkmcnt(0)
    s_barrier
    v_mfma_f32_16x16x32_bf16 v[72:75], v[144:147], v[176:179], v[72:75]
    ds_read_b128 v[160:163], v44 offset:0
    ds_read_b128 v[164:167], v44 offset:2048
    v_mfma_f32_16x16x32_bf16 v[76:79], v[144:147], v[180:183], v[76:79]
    ds_read_b64_tr_b16 v[128:129], v56 offset:0
    buffer_load_dwordx4 v16, s[44:47], s40 offen offset:2048  lds
    v_mfma_f32_16x16x32_bf16 v[88:91], v[148:151], v[176:179], v[88:91]
    ds_read_b64_tr_b16 v[130:131], v56 offset:1024
    ds_read_b64_tr_b16 v[132:133], v57 offset:0
    v_mfma_f32_16x16x32_bf16 v[92:95], v[148:151], v[180:183], v[92:95]
    buffer_load_dwordx4 v17, s[44:47], s40 offen offset:3072  lds
    v_mfma_f32_16x16x32_bf16 v[104:107], v[152:155], v[176:179], v[104:107]
    ds_read_b64_tr_b16 v[134:135], v57 offset:1024
    ds_read_b64_tr_b16 v[136:137], v58 offset:0
    v_mfma_f32_16x16x32_bf16 v[108:111], v[152:155], v[180:183], v[108:111]
    ds_read_b64_tr_b16 v[138:139], v58 offset:1024
    s_add_u32 s39, s28, 6
    s_and_b32 s39, s39, 15
    s_add_u32 m0, s43, 32768
    s_lshl_b32 s40, s39, 19
    buffer_load_dwordx4 v10, s[48:51], s40 offen offset:0  lds
    v_mfma_f32_16x16x32_bf16 v[120:123], v[156:159], v[176:179], v[120:123]
    ds_read_b64_tr_b16 v[140:141], v59 offset:0
    ds_read_b64_tr_b16 v[142:143], v59 offset:1024
    v_mfma_f32_16x16x32_bf16 v[124:127], v[156:159], v[180:183], v[124:127]
    buffer_load_dwordx4 v11, s[48:51], s40 offen offset:1024  lds
    s_waitcnt lgkmcnt(6)
    v_mfma_f32_16x16x32_bf16 v[64:67], v[128:131], v[160:163], v[64:67]
    ds_read_b64_tr_b16 v[144:145], v32 offset:0
    ds_read_b64_tr_b16 v[146:147], v32 offset:1024
    v_mfma_f32_16x16x32_bf16 v[68:71], v[128:131], v[164:167], v[68:71]
    ds_read_b64_tr_b16 v[148:149], v33 offset:0
    buffer_store_dwordx4 v[172:175], v1, s[64:67], s4 offen offset:0 sc1
    s_waitcnt lgkmcnt(7)
    v_mfma_f32_16x16x32_bf16 v[80:83], v[132:135], v[160:163], v[80:83]
    ds_read_b64_tr_b16 v[150:151], v33 offset:1024
    ds_read_b64_tr_b16 v[152:153], v34 offset:0
    v_mfma_f32_16x16x32_bf16 v[84:87], v[132:135], v[164:167], v[84:87]
    buffer_load_dwordx4 v12, s[48:51], s40 offen offset:2048  lds
    s_waitcnt lgkmcnt(7)
    v_mfma_f32_16x16x32_bf16 v[96:99], v[136:139], v[160:163], v[96:99]
    ds_read_b64_tr_b16 v[154:155], v34 offset:1024
    ds_read_b64_tr_b16 v[156:157], v35 offset:0
    v_mfma_f32_16x16x32_bf16 v[100:103], v[136:139], v[164:167], v[100:103]
    ds_read_b64_tr_b16 v[158:159], v35 offset:1024
    s_waitcnt lgkmcnt(8)
    v_mfma_f32_16x16x32_bf16 v[112:115], v[140:143], v[160:163], v[112:115]
    v_mfma_f32_16x16x32_bf16 v[116:119], v[140:143], v[164:167], v[116:119]
    buffer_load_dwordx4 v13, s[48:51], s40 offen offset:3072  lds
    s_waitcnt lgkmcnt(6)
    v_mfma_f32_16x16x32_bf16 v[72:75], v[144:147], v[160:163], v[72:75]
    ds_read_b128 v[176:179], v46 offset:0
    ds_read_b128 v[180:183], v46 offset:2048
    v_mfma_f32_16x16x32_bf16 v[76:79], v[144:147], v[164:167], v[76:79]
    ds_read_b64_tr_b16 v[128:129], v56 offset:8192
    s_waitcnt lgkmcnt(7)
    v_mfma_f32_16x16x32_bf16 v[88:91], v[148:151], v[160:163], v[88:91]
    ds_read_b64_tr_b16 v[130:131], v56 offset:9216
    ds_read_b64_tr_b16 v[132:133], v57 offset:8192
    v_mfma_f32_16x16x32_bf16 v[92:95], v[148:151], v[164:167], v[92:95]
    s_add_u32 m0, s43, 49152
    s_lshl_b32 s40, s39, 7
    buffer_load_dwordx4 v14, s[44:47], s40 offen offset:0  lds
    s_waitcnt lgkmcnt(7)
    v_mfma_f32_16x16x32_bf16 v[104:107], v[152:155], v[160:163], v[104:107]
    ds_read_b64_tr_b16 v[134:135], v57 offset:9216
    ds_read_b64_tr_b16 v[136:137], v58 offset:8192
    v_mfma_f32_16x16x32_bf16 v[108:111], v[152:155], v[164:167], v[108:111]
    ds_read_b64_tr_b16 v[138:139], v58 offset:9216
    s_waitcnt lgkmcnt(8)
    v_mfma_f32_16x16x32_bf16 v[120:123], v[156:159], v[160:163], v[120:123]
    ds_read_b64_tr_b16 v[140:141], v59 offset:8192
    ds_read_b64_tr_b16 v[142:143], v59 offset:9216
    v_mfma_f32_16x16x32_bf16 v[124:127], v[156:159], v[164:167], v[124:127]
    buffer_load_dwordx4 v15, s[44:47], s40 offen offset:1024  lds
    s_waitcnt lgkmcnt(6)
    v_mfma_f32_16x16x32_bf16 v[64:67], v[128:131], v[176:179], v[64:67]
    ds_read_b64_tr_b16 v[144:145], v32 offset:8192
    ds_read_b64_tr_b16 v[146:147], v32 offset:9216
    v_mfma_f32_16x16x32_bf16 v[68:71], v[128:131], v[180:183], v[68:71]
    ds_read_b64_tr_b16 v[148:149], v33 offset:8192
    buffer_store_dwordx4 v[172:175], v1, s[64:67], s4 offen offset:1024 sc1
    s_waitcnt lgkmcnt(7)
    v_mfma_f32_16x16x32_bf16 v[80:83], v[132:135], v[176:179], v[80:83]
    ds_read_b64_tr_b16 v[150:151], v33 offset:9216
    ds_read_b64_tr_b16 v[152:153], v34 offset:8192
    v_mfma_f32_16x16x32_bf16 v[84:87], v[132:135], v[180:183], v[84:87]
    buffer_load_dwordx4 v16, s[44:47], s40 offen offset:2048  lds
    s_waitcnt lgkmcnt(7)
    v_mfma_f32_16x16x32_bf16 v[96:99], v[136:139], v[176:179], v[96:99]
    ds_read_b64_tr_b16 v[154:155], v34 offset:9216
    ds_read_b64_tr_b16 v[156:157], v35 offset:8192
    v_mfma_f32_16x16x32_bf16 v[100:103], v[136:139], v[180:183], v[100:103]
    ds_read_b64_tr_b16 v[158:159], v35 offset:9216
    s_waitcnt lgkmcnt(8)
    v_mfma_f32_16x16x32_bf16 v[112:115], v[140:143], v[176:179], v[112:115]
    v_mfma_f32_16x16x32_bf16 v[116:119], v[140:143], v[180:183], v[116:119]
    buffer_load_dwordx4 v17, s[44:47], s40 offen offset:3072  lds
    s_waitcnt vmcnt(26) lgkmcnt(0)
    s_barrier
    v_mfma_f32_16x16x32_bf16 v[72:75], v[144:147], v[176:179], v[72:75]
    ds_read_b128 v[160:163], v44 offset:32768
    ds_read_b128 v[164:167], v44 offset:34816
    v_mfma_f32_16x16x32_bf16 v[76:79], v[144:147], v[180:183], v[76:79]
    ds_read_b64_tr_b16 v[128:129], v56 offset:32768
    v_mfma_f32_16x16x32_bf16 v[88:91], v[148:151], v[176:179], v[88:91]
    ds_read_b64_tr_b16 v[130:131], v56 offset:33792
    ds_read_b64_tr_b16 v[132:133], v57 offset:32768
    v_mfma_f32_16x16x32_bf16 v[92:95], v[148:151], v[180:183], v[92:95]
    s_add_u32 s39, s28, 7
    s_and_b32 s39, s39, 15
    s_add_u32 m0, s43, 65536
    s_lshl_b32 s40, s39, 19
    buffer_load_dwordx4 v10, s[48:51], s40 offen offset:0  lds
    v_mfma_f32_16x16x32_bf16 v[104:107], v[152:155], v[176:179], v[104:107]
    ds_read_b64_tr_b16 v[134:135], v57 offset:33792
    ds_read_b64_tr_b16 v[136:137], v58 offset:32768
    v_mfma_f32_16x16x32_bf16 v[108:111], v[152:155], v[180:183], v[108:111]
    ds_read_b64_tr_b16 v[138:139], v58 offset:33792
    v_mfma_f32_16x16x32_bf16 v[120:123], v[156:159], v[176:179], v[120:123]
    ds_read_b64_tr_b16 v[140:141], v59 offset:32768
    ds_read_b64_tr_b16 v[142:143], v59 offset:33792
    v_mfma_f32_16x16x32_bf16 v[124:127], v[156:159], v[180:183], v[124:127]
    buffer_load_dwordx4 v11, s[48:51], s40 offen offset:1024  lds
    s_waitcnt lgkmcnt(6)
    v_mfma_f32_16x16x32_bf16 v[64:67], v[128:131], v[160:163], v[64:67]
    ds_read_b64_tr_b16 v[144:145], v32 offset:32768
    ds_read_b64_tr_b16 v[146:147], v32 offset:33792
    v_mfma_f32_16x16x32_bf16 v[68:71], v[128:131], v[164:167], v[68:71]
    ds_read_b64_tr_b16 v[148:149], v33 offset:32768
    buffer_store_dwordx4 v[172:175], v1, s[64:67], s4 offen offset:2048 sc1
    s_waitcnt lgkmcnt(7)
    v_mfma_f32_16x16x32_bf16 v[80:83], v[132:135], v[160:163], v[80:83]
    ds_read_b64_tr_b16 v[150:151], v33 offset:33792
    ds_read_b64_tr_b16 v[152:153], v34 offset:32768
    v_mfma_f32_16x16x32_bf16 v[84:87], v[132:135], v[164:167], v[84:87]
    buffer_load_dwordx4 v12, s[48:51], s40 offen offset:2048  lds
    s_waitcnt lgkmcnt(7)
    v_mfma_f32_16x16x32_bf16 v[96:99], v[136:139], v[160:163], v[96:99]
    ds_read_b64_tr_b16 v[154:155], v34 offset:33792
    ds_read_b64_tr_b16 v[156:157], v35 offset:32768
    v_mfma_f32_16x16x32_bf16 v[100:103], v[136:139], v[164:167], v[100:103]
    ds_read_b64_tr_b16 v[158:159], v35 offset:33792
    s_waitcnt lgkmcnt(8)
    v_mfma_f32_16x16x32_bf16 v[112:115], v[140:143], v[160:163], v[112:115]
    v_mfma_f32_16x16x32_bf16 v[116:119], v[140:143], v[164:167], v[116:119]
    buffer_load_dwordx4 v13, s[48:51], s40 offen offset:3072  lds
    s_waitcnt lgkmcnt(6)
    v_mfma_f32_16x16x32_bf16 v[72:75], v[144:147], v[160:163], v[72:75]
    ds_read_b128 v[176:179], v46 offset:32768
    ds_read_b128 v[180:183], v46 offset:34816
    v_mfma_f32_16x16x32_bf16 v[76:79], v[144:147], v[164:167], v[76:79]
    ds_read_b64_tr_b16 v[128:129], v56 offset:40960
    s_waitcnt lgkmcnt(7)
    v_mfma_f32_16x16x32_bf16 v[88:91], v[148:151], v[160:163], v[88:91]
    ds_read_b64_tr_b16 v[130:131], v56 offset:41984
    ds_read_b64_tr_b16 v[132:133], v57 offset:40960
    v_mfma_f32_16x16x32_bf16 v[92:95], v[148:151], v[164:167], v[92:95]
    s_add_u32 m0, s43, 81920
    s_lshl_b32 s40, s39, 7
    buffer_load_dwordx4 v14, s[44:47], s40 offen offset:0  lds
    s_waitcnt lgkmcnt(7)
    v_mfma_f32_16x16x32_bf16 v[104:107], v[152:155], v[160:163], v[104:107]
    ds_read_b64_tr_b16 v[134:135], v57 offset:41984
    ds_read_b64_tr_b16 v[136:137], v58 offset:40960
    v_mfma_f32_16x16x32_bf16 v[108:111], v[152:155], v[164:167], v[108:111]
    ds_read_b64_tr_b16 v[138:139], v58 offset:41984
    s_waitcnt lgkmcnt(8)
    v_mfma_f32_16x16x32_bf16 v[120:123], v[156:159], v[160:163], v[120:123]
    ds_read_b64_tr_b16 v[140:141], v59 offset:40960
    ds_read_b64_tr_b16 v[142:143], v59 offset:41984
    v_mfma_f32_16x16x32_bf16 v[124:127], v[156:159], v[164:167], v[124:127]
    buffer_load_dwordx4 v15, s[44:47], s40 offen offset:1024  lds
    s_waitcnt lgkmcnt(6)
    v_mfma_f32_16x16x32_bf16 v[64:67], v[128:131], v[176:179], v[64:67]
    ds_read_b64_tr_b16 v[144:145], v32 offset:40960
    ds_read_b64_tr_b16 v[146:147], v32 offset:41984
    v_mfma_f32_16x16x32_bf16 v[68:71], v[128:131], v[180:183], v[68:71]
    ds_read_b64_tr_b16 v[148:149], v33 offset:40960
    buffer_store_dwordx4 v[172:175], v1, s[64:67], s4 offen offset:3072 sc1
    s_waitcnt lgkmcnt(7)
    v_mfma_f32_16x16x32_bf16 v[80:83], v[132:135], v[176:179], v[80:83]
    ds_read_b64_tr_b16 v[150:151], v33 offset:41984
    ds_read_b64_tr_b16 v[152:153], v34 offset:40960
    v_mfma_f32_16x16x32_bf16 v[84:87], v[132:135], v[180:183], v[84:87]
    buffer_load_dwordx4 v16, s[44:47], s40 offen offset:2048  lds
    s_waitcnt lgkmcnt(7)
    v_mfma_f32_16x16x32_bf16 v[96:99], v[136:139], v[176:179], v[96:99]
    ds_read_b64_tr_b16 v[154:155], v34 offset:41984
    ds_read_b64_tr_b16 v[156:157], v35 offset:40960
    v_mfma_f32_16x16x32_bf16 v[100:103], v[136:139], v[180:183], v[100:103]
    ds_read_b64_tr_b16 v[158:159], v35 offset:41984
    s_waitcnt lgkmcnt(8)
    v_mfma_f32_16x16x32_bf16 v[112:115], v[140:143], v[176:179], v[112:115]
    v_mfma_f32_16x16x32_bf16 v[116:119], v[140:143], v[180:183], v[116:119]
    buffer_load_dwordx4 v17, s[44:47], s40 offen offset:3072  lds
    s_waitcnt vmcnt(28) lgkmcnt(0)
    s_barrier
    v_mfma_f32_16x16x32_bf16 v[72:75], v[144:147], v[176:179], v[72:75]
    ds_read_b128 v[160:163], v48 offset:0
    ds_read_b128 v[164:167], v48 offset:2048
    v_mfma_f32_16x16x32_bf16 v[76:79], v[144:147], v[180:183], v[76:79]
    ds_read_b64_tr_b16 v[128:129], v60 offset:0
    v_mfma_f32_16x16x32_bf16 v[88:91], v[148:151], v[176:179], v[88:91]
    ds_read_b64_tr_b16 v[130:131], v60 offset:1024
    ds_read_b64_tr_b16 v[132:133], v61 offset:0
    v_mfma_f32_16x16x32_bf16 v[92:95], v[148:151], v[180:183], v[92:95]
    s_add_u32 s39, s28, 8
    s_and_b32 s39, s39, 15
    s_add_u32 m0, s43, 98304
    s_lshl_b32 s40, s39, 19
    buffer_load_dwordx4 v10, s[48:51], s40 offen offset:0  lds
    v_mfma_f32_16x16x32_bf16 v[104:107], v[152:155], v[176:179], v[104:107]
    ds_read_b64_tr_b16 v[134:135], v61 offset:1024
    ds_read_b64_tr_b16 v[136:137], v62 offset:0
    v_mfma_f32_16x16x32_bf16 v[108:111], v[152:155], v[180:183], v[108:111]
    ds_read_b64_tr_b16 v[138:139], v62 offset:1024
    v_mfma_f32_16x16x32_bf16 v[120:123], v[156:159], v[176:179], v[120:123]
    ds_read_b64_tr_b16 v[140:141], v63 offset:0
    ds_read_b64_tr_b16 v[142:143], v63 offset:1024
    v_mfma_f32_16x16x32_bf16 v[124:127], v[156:159], v[180:183], v[124:127]
    buffer_load_dwordx4 v11, s[48:51], s40 offen offset:1024  lds
    s_waitcnt lgkmcnt(6)
    v_mfma_f32_16x16x32_bf16 v[64:67], v[128:131], v[160:163], v[64:67]
    ds_read_b64_tr_b16 v[144:145], v36 offset:0
    ds_read_b64_tr_b16 v[146:147], v36 offset:1024
    v_mfma_f32_16x16x32_bf16 v[68:71], v[128:131], v[164:167], v[68:71]
    ds_read_b64_tr_b16 v[148:149], v37 offset:0
    buffer_store_dwordx4 v[172:175], v1, s[64:67], s5 offen offset:0 sc1
    s_waitcnt lgkmcnt(7)
    v_mfma_f32_16x16x32_bf16 v[80:83], v[132:135], v[160:163], v[80:83]
    ds_read_b64_tr_b16 v[150:151], v37 offset:1024
    ds_read_b64_tr_b16 v[152:153], v38 offset:0
    v_mfma_f32_16x16x32_bf16 v[84:87], v[132:135], v[164:167], v[84:87]
    buffer_load_dwordx4 v12, s[48:51], s40 offen offset:2048  lds
    s_waitcnt lgkmcnt(7)
    v_mfma_f32_16x16x32_bf16 v[96:99], v[136:139], v[160:163], v[96:99]
    ds_read_b64_tr_b16 v[154:155], v38 offset:1024
    ds_read_b64_tr_b16 v[156:157], v39 offset:0
    v_mfma_f32_16x16x32_bf16 v[100:103], v[136:139], v[164:167], v[100:103]
    ds_read_b64_tr_b16 v[158:159], v39 offset:1024
    s_waitcnt lgkmcnt(8)
    v_mfma_f32_16x16x32_bf16 v[112:115], v[140:143], v[160:163], v[112:115]
    v_mfma_f32_16x16x32_bf16 v[116:119], v[140:143], v[164:167], v[116:119]
    buffer_load_dwordx4 v13, s[48:51], s40 offen offset:3072  lds
    s_waitcnt lgkmcnt(6)
    v_mfma_f32_16x16x32_bf16 v[72:75], v[144:147], v[160:163], v[72:75]
    ds_read_b128 v[176:179], v50 offset:0
    ds_read_b128 v[180:183], v50 offset:2048
    v_mfma_f32_16x16x32_bf16 v[76:79], v[144:147], v[164:167], v[76:79]
    ds_read_b64_tr_b16 v[128:129], v60 offset:8192
    s_waitcnt lgkmcnt(7)
    v_mfma_f32_16x16x32_bf16 v[88:91], v[148:151], v[160:163], v[88:91]
    ds_read_b64_tr_b16 v[130:131], v60 offset:9216
    ds_read_b64_tr_b16 v[132:133], v61 offset:8192
    v_mfma_f32_16x16x32_bf16 v[92:95], v[148:151], v[164:167], v[92:95]
    s_add_u32 m0, s43, 114688
    s_lshl_b32 s40, s39, 7
    buffer_load_dwordx4 v14, s[44:47], s40 offen offset:0  lds
    s_waitcnt lgkmcnt(7)
    v_mfma_f32_16x16x32_bf16 v[104:107], v[152:155], v[160:163], v[104:107]
    ds_read_b64_tr_b16 v[134:135], v61 offset:9216
    ds_read_b64_tr_b16 v[136:137], v62 offset:8192
    v_mfma_f32_16x16x32_bf16 v[108:111], v[152:155], v[164:167], v[108:111]
    ds_read_b64_tr_b16 v[138:139], v62 offset:9216
    s_waitcnt lgkmcnt(8)
    v_mfma_f32_16x16x32_bf16 v[120:123], v[156:159], v[160:163], v[120:123]
    ds_read_b64_tr_b16 v[140:141], v63 offset:8192
    ds_read_b64_tr_b16 v[142:143], v63 offset:9216
    v_mfma_f32_16x16x32_bf16 v[124:127], v[156:159], v[164:167], v[124:127]
    buffer_load_dwordx4 v15, s[44:47], s40 offen offset:1024  lds
    s_waitcnt lgkmcnt(6)
    v_mfma_f32_16x16x32_bf16 v[64:67], v[128:131], v[176:179], v[64:67]
    ds_read_b64_tr_b16 v[144:145], v36 offset:8192
    ds_read_b64_tr_b16 v[146:147], v36 offset:9216
    v_mfma_f32_16x16x32_bf16 v[68:71], v[128:131], v[180:183], v[68:71]
    ds_read_b64_tr_b16 v[148:149], v37 offset:8192
    buffer_store_dwordx4 v[172:175], v1, s[64:67], s5 offen offset:1024 sc1
    s_waitcnt lgkmcnt(7)
    v_mfma_f32_16x16x32_bf16 v[80:83], v[132:135], v[176:179], v[80:83]
    ds_read_b64_tr_b16 v[150:151], v37 offset:9216
    ds_read_b64_tr_b16 v[152:153], v38 offset:8192
    v_mfma_f32_16x16x32_bf16 v[84:87], v[132:135], v[180:183], v[84:87]
    buffer_load_dwordx4 v16, s[44:47], s40 offen offset:2048  lds
    s_waitcnt lgkmcnt(7)
    v_mfma_f32_16x16x32_bf16 v[96:99], v[136:139], v[176:179], v[96:99]
    ds_read_b64_tr_b16 v[154:155], v38 offset:9216
    ds_read_b64_tr_b16 v[156:157], v39 offset:8192
    v_mfma_f32_16x16x32_bf16 v[100:103], v[136:139], v[180:183], v[100:103]
    ds_read_b64_tr_b16 v[158:159], v39 offset:9216
    s_waitcnt lgkmcnt(8)
    v_mfma_f32_16x16x32_bf16 v[112:115], v[140:143], v[176:179], v[112:115]
    v_mfma_f32_16x16x32_bf16 v[116:119], v[140:143], v[180:183], v[116:119]
    buffer_load_dwordx4 v17, s[44:47], s40 offen offset:3072  lds
    s_waitcnt vmcnt(30) lgkmcnt(0)
    s_barrier
    buffer_load_dword v203, v201, s[16:19], 0 offen sc1
    v_mfma_f32_16x16x32_bf16 v[72:75], v[144:147], v[176:179], v[72:75]
    ds_read_b128 v[160:163], v40 offset:0
    ds_read_b128 v[164:167], v40 offset:2048
    v_mfma_f32_16x16x32_bf16 v[76:79], v[144:147], v[180:183], v[76:79]
    ds_read_b64_tr_b16 v[128:129], v52 offset:0
    v_mfma_f32_16x16x32_bf16 v[88:91], v[148:151], v[176:179], v[88:91]
    ds_read_b64_tr_b16 v[130:131], v52 offset:1024
    ds_read_b64_tr_b16 v[132:133], v53 offset:0
    v_mfma_f32_16x16x32_bf16 v[92:95], v[148:151], v[180:183], v[92:95]
    s_add_u32 s39, s28, 9
    s_and_b32 s39, s39, 15
    s_add_u32 m0, s43, 131072
    s_lshl_b32 s40, s39, 19
    buffer_load_dwordx4 v10, s[48:51], s40 offen offset:0  lds
    v_mfma_f32_16x16x32_bf16 v[104:107], v[152:155], v[176:179], v[104:107]
    ds_read_b64_tr_b16 v[134:135], v53 offset:1024
    ds_read_b64_tr_b16 v[136:137], v54 offset:0
    v_mfma_f32_16x16x32_bf16 v[108:111], v[152:155], v[180:183], v[108:111]
    ds_read_b64_tr_b16 v[138:139], v54 offset:1024
    v_mfma_f32_16x16x32_bf16 v[120:123], v[156:159], v[176:179], v[120:123]
    ds_read_b64_tr_b16 v[140:141], v55 offset:0
    ds_read_b64_tr_b16 v[142:143], v55 offset:1024
    v_mfma_f32_16x16x32_bf16 v[124:127], v[156:159], v[180:183], v[124:127]
    buffer_load_dwordx4 v11, s[48:51], s40 offen offset:1024  lds
    s_waitcnt lgkmcnt(6)
    v_mfma_f32_16x16x32_bf16 v[64:67], v[128:131], v[160:163], v[64:67]
    ds_read_b64_tr_b16 v[144:145], v28 offset:0
    ds_read_b64_tr_b16 v[146:147], v28 offset:1024
    v_mfma_f32_16x16x32_bf16 v[68:71], v[128:131], v[164:167], v[68:71]
    ds_read_b64_tr_b16 v[148:149], v29 offset:0
    s_waitcnt lgkmcnt(7)
    v_mfma_f32_16x16x32_bf16 v[80:83], v[132:135], v[160:163], v[80:83]
    ds_read_b64_tr_b16 v[150:151], v29 offset:1024
    ds_read_b64_tr_b16 v[152:153], v30 offset:0
    v_mfma_f32_16x16x32_bf16 v[84:87], v[132:135], v[164:167], v[84:87]
    buffer_load_dwordx4 v12, s[48:51], s40 offen offset:2048  lds
    s_waitcnt lgkmcnt(7)
    v_mfma_f32_16x16x32_bf16 v[96:99], v[136:139], v[160:163], v[96:99]
    ds_read_b64_tr_b16 v[154:155], v30 offset:1024
    ds_read_b64_tr_b16 v[156:157], v31 offset:0
    v_mfma_f32_16x16x32_bf16 v[100:103], v[136:139], v[164:167], v[100:103]
    ds_read_b64_tr_b16 v[158:159], v31 offset:1024
    s_waitcnt lgkmcnt(8)
    v_mfma_f32_16x16x32_bf16 v[112:115], v[140:143], v[160:163], v[112:115]
    v_mfma_f32_16x16x32_bf16 v[116:119], v[140:143], v[164:167], v[116:119]
    buffer_load_dwordx4 v13, s[48:51], s40 offen offset:3072  lds
    s_waitcnt lgkmcnt(6)
    v_mfma_f32_16x16x32_bf16 v[72:75], v[144:147], v[160:163], v[72:75]
    ds_read_b128 v[176:179], v42 offset:0
    ds_read_b128 v[180:183], v42 offset:2048
    v_mfma_f32_16x16x32_bf16 v[76:79], v[144:147], v[164:167], v[76:79]
    ds_read_b64_tr_b16 v[128:129], v52 offset:8192
    s_waitcnt lgkmcnt(7)
    v_mfma_f32_16x16x32_bf16 v[88:91], v[148:151], v[160:163], v[88:91]
    ds_read_b64_tr_b16 v[130:131], v52 offset:9216
    ds_read_b64_tr_b16 v[132:133], v53 offset:8192
    v_mfma_f32_16x16x32_bf16 v[92:95], v[148:151], v[164:167], v[92:95]
    s_add_u32 m0, s43, 147456
    s_lshl_b32 s40, s39, 7
    buffer_load_dwordx4 v14, s[44:47], s40 offen offset:0  lds
    s_waitcnt lgkmcnt(7)
    v_mfma_f32_16x16x32_bf16 v[104:107], v[152:155], v[160:163], v[104:107]
    ds_read_b64_tr_b16 v[134:135], v53 offset:9216
    ds_read_b64_tr_b16 v[136:137], v54 offset:8192
    v_mfma_f32_16x16x32_bf16 v[108:111], v[152:155], v[164:167], v[108:111]
    ds_read_b64_tr_b16 v[138:139], v54 offset:9216
    s_waitcnt lgkmcnt(8)
    v_mfma_f32_16x16x32_bf16 v[120:123], v[156:159], v[160:163], v[120:123]
    ds_read_b64_tr_b16 v[140:141], v55 offset:8192
    ds_read_b64_tr_b16 v[142:143], v55 offset:9216
    v_mfma_f32_16x16x32_bf16 v[124:127], v[156:159], v[164:167], v[124:127]
    buffer_load_dwordx4 v15, s[44:47], s40 offen offset:1024  lds
    s_waitcnt lgkmcnt(6)
    v_mfma_f32_16x16x32_bf16 v[64:67], v[128:131], v[176:179], v[64:67]
    ds_read_b64_tr_b16 v[144:145], v28 offset:8192
    ds_read_b64_tr_b16 v[146:147], v28 offset:9216
    v_mfma_f32_16x16x32_bf16 v[68:71], v[128:131], v[180:183], v[68:71]
    ds_read_b64_tr_b16 v[148:149], v29 offset:8192
    s_waitcnt lgkmcnt(7)
    v_mfma_f32_16x16x32_bf16 v[80:83], v[132:135], v[176:179], v[80:83]
    ds_read_b64_tr_b16 v[150:151], v29 offset:9216
    ds_read_b64_tr_b16 v[152:153], v30 offset:8192
    v_mfma_f32_16x16x32_bf16 v[84:87], v[132:135], v[180:183], v[84:87]
    buffer_load_dwordx4 v16, s[44:47], s40 offen offset:2048  lds
    s_waitcnt lgkmcnt(7)
    v_mfma_f32_16x16x32_bf16 v[96:99], v[136:139], v[176:179], v[96:99]
    ds_read_b64_tr_b16 v[154:155], v30 offset:9216
    ds_read_b64_tr_b16 v[156:157], v31 offset:8192
    v_mfma_f32_16x16x32_bf16 v[100:103], v[136:139], v[180:183], v[100:103]
    ds_read_b64_tr_b16 v[158:159], v31 offset:9216
    s_waitcnt lgkmcnt(8)
    v_mfma_f32_16x16x32_bf16 v[112:115], v[140:143], v[176:179], v[112:115]
    v_mfma_f32_16x16x32_bf16 v[116:119], v[140:143], v[180:183], v[116:119]
    buffer_load_dwordx4 v17, s[44:47], s40 offen offset:3072  lds
    s_waitcnt vmcnt(29) lgkmcnt(0)
    s_barrier
    v_mfma_f32_16x16x32_bf16 v[72:75], v[144:147], v[176:179], v[72:75]
    ds_read_b128 v[160:163], v40 offset:32768
    ds_read_b128 v[164:167], v40 offset:34816
    v_mfma_f32_16x16x32_bf16 v[76:79], v[144:147], v[180:183], v[76:79]
    ds_read_b64_tr_b16 v[128:129], v52 offset:32768
    v_mfma_f32_16x16x32_bf16 v[88:91], v[148:151], v[176:179], v[88:91]
    ds_read_b64_tr_b16 v[130:131], v52 offset:33792
    ds_read_b64_tr_b16 v[132:133], v53 offset:32768
    v_mfma_f32_16x16x32_bf16 v[92:95], v[148:151], v[180:183], v[92:95]
    s_add_u32 s39, s28, 10
    s_and_b32 s39, s39, 15
    s_add_u32 m0, s43, 0
    s_lshl_b32 s40, s39, 19
    buffer_load_dwordx4 v10, s[48:51], s40 offen offset:0  lds
    v_mfma_f32_16x16x32_bf16 v[104:107], v[152:155], v[176:179], v[104:107]
    ds_read_b64_tr_b16 v[134:135], v53 offset:33792
    ds_read_b64_tr_b16 v[136:137], v54 offset:32768
    v_mfma_f32_16x16x32_bf16 v[108:111], v[152:155], v[180:183], v[108:111]
    ds_read_b64_tr_b16 v[138:139], v54 offset:33792
    v_mfma_f32_16x16x32_bf16 v[120:123], v[156:159], v[176:179], v[120:123]
    ds_read_b64_tr_b16 v[140:141], v55 offset:32768
    ds_read_b64_tr_b16 v[142:143], v55 offset:33792
    v_mfma_f32_16x16x32_bf16 v[124:127], v[156:159], v[180:183], v[124:127]
    buffer_load_dwordx4 v11, s[48:51], s40 offen offset:1024  lds
    s_waitcnt lgkmcnt(6)
    v_mfma_f32_16x16x32_bf16 v[64:67], v[128:131], v[160:163], v[64:67]
    ds_read_b64_tr_b16 v[144:145], v28 offset:32768
    ds_read_b64_tr_b16 v[146:147], v28 offset:33792
    v_mfma_f32_16x16x32_bf16 v[68:71], v[128:131], v[164:167], v[68:71]
    ds_read_b64_tr_b16 v[148:149], v29 offset:32768
    s_waitcnt lgkmcnt(7)
    v_mfma_f32_16x16x32_bf16 v[80:83], v[132:135], v[160:163], v[80:83]
    ds_read_b64_tr_b16 v[150:151], v29 offset:33792
    ds_read_b64_tr_b16 v[152:153], v30 offset:32768
    v_mfma_f32_16x16x32_bf16 v[84:87], v[132:135], v[164:167], v[84:87]
    buffer_load_dwordx4 v12, s[48:51], s40 offen offset:2048  lds
    s_waitcnt lgkmcnt(7)
    v_mfma_f32_16x16x32_bf16 v[96:99], v[136:139], v[160:163], v[96:99]
    ds_read_b64_tr_b16 v[154:155], v30 offset:33792
    ds_read_b64_tr_b16 v[156:157], v31 offset:32768
    v_mfma_f32_16x16x32_bf16 v[100:103], v[136:139], v[164:167], v[100:103]
    ds_read_b64_tr_b16 v[158:159], v31 offset:33792
    s_waitcnt lgkmcnt(8)
    v_mfma_f32_16x16x32_bf16 v[112:115], v[140:143], v[160:163], v[112:115]
    v_mfma_f32_16x16x32_bf16 v[116:119], v[140:143], v[164:167], v[116:119]
    buffer_load_dwordx4 v13, s[48:51], s40 offen offset:3072  lds
    s_waitcnt lgkmcnt(6)
    v_mfma_f32_16x16x32_bf16 v[72:75], v[144:147], v[160:163], v[72:75]
    ds_read_b128 v[176:179], v42 offset:32768
    ds_read_b128 v[180:183], v42 offset:34816
    v_mfma_f32_16x16x32_bf16 v[76:79], v[144:147], v[164:167], v[76:79]
    ds_read_b64_tr_b16 v[128:129], v52 offset:40960
    s_waitcnt lgkmcnt(7)
    v_mfma_f32_16x16x32_bf16 v[88:91], v[148:151], v[160:163], v[88:91]
    ds_read_b64_tr_b16 v[130:131], v52 offset:41984
    ds_read_b64_tr_b16 v[132:133], v53 offset:40960
    v_mfma_f32_16x16x32_bf16 v[92:95], v[148:151], v[164:167], v[92:95]
    s_add_u32 m0, s43, 16384
    s_lshl_b32 s40, s39, 7
    buffer_load_dwordx4 v14, s[44:47], s40 offen offset:0  lds
    s_waitcnt lgkmcnt(7)
    v_mfma_f32_16x16x32_bf16 v[104:107], v[152:155], v[160:163], v[104:107]
    ds_read_b64_tr_b16 v[134:135], v53 offset:41984
    ds_read_b64_tr_b16 v[136:137], v54 offset:40960
    v_mfma_f32_16x16x32_bf16 v[108:111], v[152:155], v[164:167], v[108:111]
    ds_read_b64_tr_b16 v[138:139], v54 offset:41984
    s_waitcnt lgkmcnt(8)
    v_mfma_f32_16x16x32_bf16 v[120:123], v[156:159], v[160:163], v[120:123]
    ds_read_b64_tr_b16 v[140:141], v55 offset:40960
    ds_read_b64_tr_b16 v[142:143], v55 offset:41984
    v_mfma_f32_16x16x32_bf16 v[124:127], v[156:159], v[164:167], v[124:127]
    buffer_load_dwordx4 v15, s[44:47], s40 offen offset:1024  lds
    s_waitcnt lgkmcnt(6)
    v_mfma_f32_16x16x32_bf16 v[64:67], v[128:131], v[176:179], v[64:67]
    ds_read_b64_tr_b16 v[144:145], v28 offset:40960
    ds_read_b64_tr_b16 v[146:147], v28 offset:41984
    v_mfma_f32_16x16x32_bf16 v[68:71], v[128:131], v[180:183], v[68:71]
    ds_read_b64_tr_b16 v[148:149], v29 offset:40960
    s_waitcnt lgkmcnt(7)
    v_mfma_f32_16x16x32_bf16 v[80:83], v[132:135], v[176:179], v[80:83]
    ds_read_b64_tr_b16 v[150:151], v29 offset:41984
    ds_read_b64_tr_b16 v[152:153], v30 offset:40960
    v_mfma_f32_16x16x32_bf16 v[84:87], v[132:135], v[180:183], v[84:87]
    buffer_load_dwordx4 v16, s[44:47], s40 offen offset:2048  lds
    s_waitcnt lgkmcnt(7)
    v_mfma_f32_16x16x32_bf16 v[96:99], v[136:139], v[176:179], v[96:99]
    ds_read_b64_tr_b16 v[154:155], v30 offset:41984
    ds_read_b64_tr_b16 v[156:157], v31 offset:40960
    v_mfma_f32_16x16x32_bf16 v[100:103], v[136:139], v[180:183], v[100:103]
    ds_read_b64_tr_b16 v[158:159], v31 offset:41984
    s_waitcnt lgkmcnt(8)
    v_mfma_f32_16x16x32_bf16 v[112:115], v[140:143], v[176:179], v[112:115]
    v_mfma_f32_16x16x32_bf16 v[116:119], v[140:143], v[180:183], v[116:119]
    buffer_load_dwordx4 v17, s[44:47], s40 offen offset:3072  lds
    s_waitcnt vmcnt(27) lgkmcnt(0)
    s_barrier
    v_mfma_f32_16x16x32_bf16 v[72:75], v[144:147], v[176:179], v[72:75]
    ds_read_b128 v[160:163], v44 offset:0
    ds_read_b128 v[164:167], v44 offset:2048
    v_mfma_f32_16x16x32_bf16 v[76:79], v[144:147], v[180:183], v[76:79]
    ds_read_b64_tr_b16 v[128:129], v56 offset:0
    v_mfma_f32_16x16x32_bf16 v[88:91], v[148:151], v[176:179], v[88:91]
    ds_read_b64_tr_b16 v[130:131], v56 offset:1024
    ds_read_b64_tr_b16 v[132:133], v57 offset:0
    v_mfma_f32_16x16x32_bf16 v[92:95], v[148:151], v[180:183], v[92:95]
    s_add_u32 s39, s28, 11
    s_and_b32 s39, s39, 15
    s_add_u32 m0, s43, 32768
    s_lshl_b32 s40, s39, 19
    buffer_load_dwordx4 v10, s[48:51], s40 offen offset:0  lds
    v_mfma_f32_16x16x32_bf16 v[104:107], v[152:155], v[176:179], v[104:107]
    ds_read_b64_tr_b16 v[134:135], v57 offset:1024
    ds_read_b64_tr_b16 v[136:137], v58 offset:0
    v_mfma_f32_16x16x32_bf16 v[108:111], v[152:155], v[180:183], v[108:111]
    ds_read_b64_tr_b16 v[138:139], v58 offset:1024
    v_mfma_f32_16x16x32_bf16 v[120:123], v[156:159], v[176:179], v[120:123]
    ds_read_b64_tr_b16 v[140:141], v59 offset:0
    ds_read_b64_tr_b16 v[142:143], v59 offset:1024
    v_mfma_f32_16x16x32_bf16 v[124:127], v[156:159], v[180:183], v[124:127]
    buffer_load_dwordx4 v11, s[48:51], s40 offen offset:1024  lds
    s_waitcnt lgkmcnt(6)
    v_mfma_f32_16x16x32_bf16 v[64:67], v[128:131], v[160:163], v[64:67]
    ds_read_b64_tr_b16 v[144:145], v32 offset:0
    ds_read_b64_tr_b16 v[146:147], v32 offset:1024
    v_mfma_f32_16x16x32_bf16 v[68:71], v[128:131], v[164:167], v[68:71]
    ds_read_b64_tr_b16 v[148:149], v33 offset:0
    s_waitcnt lgkmcnt(7)
    v_mfma_f32_16x16x32_bf16 v[80:83], v[132:135], v[160:163], v[80:83]
    ds_read_b64_tr_b16 v[150:151], v33 offset:1024
    ds_read_b64_tr_b16 v[152:153], v34 offset:0
    v_mfma_f32_16x16x32_bf16 v[84:87], v[132:135], v[164:167], v[84:87]
    buffer_load_dwordx4 v12, s[48:51], s40 offen offset:2048  lds
    s_waitcnt lgkmcnt(7)
    v_mfma_f32_16x16x32_bf16 v[96:99], v[136:139], v[160:163], v[96:99]
    ds_read_b64_tr_b16 v[154:155], v34 offset:1024
    ds_read_b64_tr_b16 v[156:157], v35 offset:0
    v_mfma_f32_16x16x32_bf16 v[100:103], v[136:139], v[164:167], v[100:103]
    ds_read_b64_tr_b16 v[158:159], v35 offset:1024
    s_waitcnt lgkmcnt(8)
    v_mfma_f32_16x16x32_bf16 v[112:115], v[140:143], v[160:163], v[112:115]
    v_mfma_f32_16x16x32_bf16 v[116:119], v[140:143], v[164:167], v[116:119]
    buffer_load_dwordx4 v13, s[48:51], s40 offen offset:3072  lds
    s_waitcnt lgkmcnt(6)
    v_mfma_f32_16x16x32_bf16 v[72:75], v[144:147], v[160:163], v[72:75]
    ds_read_b128 v[176:179], v46 offset:0
    ds_read_b128 v[180:183], v46 offset:2048
    v_mfma_f32_16x16x32_bf16 v[76:79], v[144:147], v[164:167], v[76:79]
    ds_read_b64_tr_b16 v[128:129], v56 offset:8192
    s_waitcnt lgkmcnt(7)
    v_mfma_f32_16x16x32_bf16 v[88:91], v[148:151], v[160:163], v[88:91]
    ds_read_b64_tr_b16 v[130:131], v56 offset:9216
    ds_read_b64_tr_b16 v[132:133], v57 offset:8192
    v_mfma_f32_16x16x32_bf16 v[92:95], v[148:151], v[164:167], v[92:95]
    s_add_u32 m0, s43, 49152
    s_lshl_b32 s40, s39, 7
    buffer_load_dwordx4 v14, s[44:47], s40 offen offset:0  lds
    s_waitcnt lgkmcnt(7)
    v_mfma_f32_16x16x32_bf16 v[104:107], v[152:155], v[160:163], v[104:107]
    ds_read_b64_tr_b16 v[134:135], v57 offset:9216
    ds_read_b64_tr_b16 v[136:137], v58 offset:8192
    v_mfma_f32_16x16x32_bf16 v[108:111], v[152:155], v[164:167], v[108:111]
    ds_read_b64_tr_b16 v[138:139], v58 offset:9216
    s_waitcnt lgkmcnt(8)
    v_mfma_f32_16x16x32_bf16 v[120:123], v[156:159], v[160:163], v[120:123]
    ds_read_b64_tr_b16 v[140:141], v59 offset:8192
    ds_read_b64_tr_b16 v[142:143], v59 offset:9216
    v_mfma_f32_16x16x32_bf16 v[124:127], v[156:159], v[164:167], v[124:127]
    buffer_load_dwordx4 v15, s[44:47], s40 offen offset:1024  lds
    s_waitcnt lgkmcnt(6)
    v_mfma_f32_16x16x32_bf16 v[64:67], v[128:131], v[176:179], v[64:67]
    ds_read_b64_tr_b16 v[144:145], v32 offset:8192
    ds_read_b64_tr_b16 v[146:147], v32 offset:9216
    v_mfma_f32_16x16x32_bf16 v[68:71], v[128:131], v[180:183], v[68:71]
    ds_read_b64_tr_b16 v[148:149], v33 offset:8192
    s_waitcnt lgkmcnt(7)
    v_mfma_f32_16x16x32_bf16 v[80:83], v[132:135], v[176:179], v[80:83]
    ds_read_b64_tr_b16 v[150:151], v33 offset:9216
    ds_read_b64_tr_b16 v[152:153], v34 offset:8192
    v_mfma_f32_16x16x32_bf16 v[84:87], v[132:135], v[180:183], v[84:87]
    buffer_load_dwordx4 v16, s[44:47], s40 offen offset:2048  lds
    s_waitcnt lgkmcnt(7)
    v_mfma_f32_16x16x32_bf16 v[96:99], v[136:139], v[176:179], v[96:99]
    ds_read_b64_tr_b16 v[154:155], v34 offset:9216
    ds_read_b64_tr_b16 v[156:157], v35 offset:8192
    v_mfma_f32_16x16x32_bf16 v[100:103], v[136:139], v[180:183], v[100:103]
    ds_read_b64_tr_b16 v[158:159], v35 offset:9216
    s_waitcnt lgkmcnt(8)
    v_mfma_f32_16x16x32_bf16 v[112:115], v[140:143], v[176:179], v[112:115]
    v_mfma_f32_16x16x32_bf16 v[116:119], v[140:143], v[180:183], v[116:119]
    buffer_load_dwordx4 v17, s[44:47], s40 offen offset:3072  lds
    s_waitcnt vmcnt(25) lgkmcnt(0)
    s_barrier
    v_mfma_f32_16x16x32_bf16 v[72:75], v[144:147], v[176:179], v[72:75]
    ds_read_b128 v[160:163], v44 offset:32768
    ds_read_b128 v[164:167], v44 offset:34816
    v_mfma_f32_16x16x32_bf16 v[76:79], v[144:147], v[180:183], v[76:79]
    ds_read_b64_tr_b16 v[128:129], v56 offset:32768
    v_mfma_f32_16x16x32_bf16 v[88:91], v[148:151], v[176:179], v[88:91]
    ds_read_b64_tr_b16 v[130:131], v56 offset:33792
    ds_read_b64_tr_b16 v[132:133], v57 offset:32768
    v_mfma_f32_16x16x32_bf16 v[92:95], v[148:151], v[180:183], v[92:95]
    s_add_u32 s39, s28, 12
    s_and_b32 s39, s39, 15
    s_add_u32 m0, s43, 65536
    s_lshl_b32 s40, s39, 19
    buffer_load_dwordx4 v10, s[48:51], s40 offen offset:0  lds
    v_mfma_f32_16x16x32_bf16 v[104:107], v[152:155], v[176:179], v[104:107]
    ds_read_b64_tr_b16 v[134:135], v57 offset:33792
    ds_read_b64_tr_b16 v[136:137], v58 offset:32768
    v_mfma_f32_16x16x32_bf16 v[108:111], v[152:155], v[180:183], v[108:111]
    ds_read_b64_tr_b16 v[138:139], v58 offset:33792
    v_mfma_f32_16x16x32_bf16 v[120:123], v[156:159], v[176:179], v[120:123]
    ds_read_b64_tr_b16 v[140:141], v59 offset:32768
    ds_read_b64_tr_b16 v[142:143], v59 offset:33792
    v_mfma_f32_16x16x32_bf16 v[124:127], v[156:159], v[180:183], v[124:127]
    buffer_load_dwordx4 v11, s[48:51], s40 offen offset:1024  lds
    s_waitcnt lgkmcnt(6)
    v_mfma_f32_16x16x32_bf16 v[64:67], v[128:131], v[160:163], v[64:67]
    ds_read_b64_tr_b16 v[144:145], v32 offset:32768
    ds_read_b64_tr_b16 v[146:147], v32 offset:33792
    v_mfma_f32_16x16x32_bf16 v[68:71], v[128:131], v[164:167], v[68:71]
    ds_read_b64_tr_b16 v[148:149], v33 offset:32768
    s_waitcnt lgkmcnt(7)
    v_mfma_f32_16x16x32_bf16 v[80:83], v[132:135], v[160:163], v[80:83]
    ds_read_b64_tr_b16 v[150:151], v33 offset:33792
    ds_read_b64_tr_b16 v[152:153], v34 offset:32768
    v_mfma_f32_16x16x32_bf16 v[84:87], v[132:135], v[164:167], v[84:87]
    buffer_load_dwordx4 v12, s[48:51], s40 offen offset:2048  lds
    s_waitcnt lgkmcnt(7)
    v_mfma_f32_16x16x32_bf16 v[96:99], v[136:139], v[160:163], v[96:99]
    ds_read_b64_tr_b16 v[154:155], v34 offset:33792
    ds_read_b64_tr_b16 v[156:157], v35 offset:32768
    v_mfma_f32_16x16x32_bf16 v[100:103], v[136:139], v[164:167], v[100:103]
    ds_read_b64_tr_b16 v[158:159], v35 offset:33792
    s_waitcnt lgkmcnt(8)
    v_mfma_f32_16x16x32_bf16 v[112:115], v[140:143], v[160:163], v[112:115]
    v_mfma_f32_16x16x32_bf16 v[116:119], v[140:143], v[164:167], v[116:119]
    buffer_load_dwordx4 v13, s[48:51], s40 offen offset:3072  lds
    s_waitcnt lgkmcnt(6)
    v_mfma_f32_16x16x32_bf16 v[72:75], v[144:147], v[160:163], v[72:75]
    ds_read_b128 v[176:179], v46 offset:32768
    ds_read_b128 v[180:183], v46 offset:34816
    v_mfma_f32_16x16x32_bf16 v[76:79], v[144:147], v[164:167], v[76:79]
    ds_read_b64_tr_b16 v[128:129], v56 offset:40960
    s_waitcnt lgkmcnt(7)
    v_mfma_f32_16x16x32_bf16 v[88:91], v[148:151], v[160:163], v[88:91]
    ds_read_b64_tr_b16 v[130:131], v56 offset:41984
    ds_read_b64_tr_b16 v[132:133], v57 offset:40960
    v_mfma_f32_16x16x32_bf16 v[92:95], v[148:151], v[164:167], v[92:95]
    s_add_u32 m0, s43, 81920
    s_lshl_b32 s40, s39, 7
    buffer_load_dwordx4 v14, s[44:47], s40 offen offset:0  lds
    s_waitcnt lgkmcnt(7)
    v_mfma_f32_16x16x32_bf16 v[104:107], v[152:155], v[160:163], v[104:107]
    ds_read_b64_tr_b16 v[134:135], v57 offset:41984
    ds_read_b64_tr_b16 v[136:137], v58 offset:40960
    v_mfma_f32_16x16x32_bf16 v[108:111], v[152:155], v[164:167], v[108:111]
    ds_read_b64_tr_b16 v[138:139], v58 offset:41984
    s_waitcnt lgkmcnt(8)
    v_mfma_f32_16x16x32_bf16 v[120:123], v[156:159], v[160:163], v[120:123]
    ds_read_b64_tr_b16 v[140:141], v59 offset:40960
    ds_read_b64_tr_b16 v[142:143], v59 offset:41984
    v_mfma_f32_16x16x32_bf16 v[124:127], v[156:159], v[164:167], v[124:127]
    buffer_load_dwordx4 v15, s[44:47], s40 offen offset:1024  lds
    s_waitcnt lgkmcnt(6)
    v_mfma_f32_16x16x32_bf16 v[64:67], v[128:131], v[176:179], v[64:67]
    ds_read_b64_tr_b16 v[144:145], v32 offset:40960
    ds_read_b64_tr_b16 v[146:147], v32 offset:41984
    v_mfma_f32_16x16x32_bf16 v[68:71], v[128:131], v[180:183], v[68:71]
    ds_read_b64_tr_b16 v[148:149], v33 offset:40960
    s_waitcnt lgkmcnt(7)
    v_mfma_f32_16x16x32_bf16 v[80:83], v[132:135], v[176:179], v[80:83]
    ds_read_b64_tr_b16 v[150:151], v33 offset:41984
    ds_read_b64_tr_b16 v[152:153], v34 offset:40960
    v_mfma_f32_16x16x32_bf16 v[84:87], v[132:135], v[180:183], v[84:87]
    buffer_load_dwordx4 v16, s[44:47], s40 offen offset:2048  lds
    s_waitcnt lgkmcnt(7)
    v_mfma_f32_16x16x32_bf16 v[96:99], v[136:139], v[176:179], v[96:99]
    ds_read_b64_tr_b16 v[154:155], v34 offset:41984
    ds_read_b64_tr_b16 v[156:157], v35 offset:40960
    v_mfma_f32_16x16x32_bf16 v[100:103], v[136:139], v[180:183], v[100:103]
    ds_read_b64_tr_b16 v[158:159], v35 offset:41984
    s_waitcnt lgkmcnt(8)
    v_mfma_f32_16x16x32_bf16 v[112:115], v[140:143], v[176:179], v[112:115]
    v_mfma_f32_16x16x32_bf16 v[116:119], v[140:143], v[180:183], v[116:119]
    buffer_load_dwordx4 v17, s[44:47], s40 offen offset:3072  lds
    s_waitcnt vmcnt(24) lgkmcnt(0)
    s_barrier
    s_cmp_lg_u32 s36, 0
    s_cbranch_scc1 L_jok
    s_mov_b32 s8, 0
L_jspin:
    v_cmp_eq_u32 vcc, 0, v203
    s_add_u32 s8, s8, 1
    s_cbranch_vccz L_jok
    s_cmp_gt_u32 s8, 0x100000
    s_cbranch_scc1 L_jok
    buffer_load_dword v203, v201, s[16:19], 0 offen sc1
    s_waitcnt vmcnt(0)
    s_branch L_jspin
L_jok:
    buffer_store_dword v204, v202, s[64:67], 0 offen sc1
    v_mfma_f32_16x16x32_bf16 v[72:75], v[144:147], v[176:179], v[72:75]
    ds_read_b128 v[160:163], v48 offset:0
    ds_read_b128 v[164:167], v48 offset:2048
    v_mfma_f32_16x16x32_bf16 v[76:79], v[144:147], v[180:183], v[76:79]
    ds_read_b64_tr_b16 v[128:129], v60 offset:0
    v_mfma_f32_16x16x32_bf16 v[88:91], v[148:151], v[176:179], v[88:91]
    ds_read_b64_tr_b16 v[130:131], v60 offset:1024
    ds_read_b64_tr_b16 v[132:133], v61 offset:0
    v_mfma_f32_16x16x32_bf16 v[92:95], v[148:151], v[180:183], v[92:95]
    s_add_u32 s39, s28, 13
    s_and_b32 s39, s39, 15
    s_add_u32 m0, s43, 98304
    s_lshl_b32 s40, s39, 19
    buffer_load_dwordx4 v10, s[48:51], s40 offen offset:0  lds
    v_mfma_f32_16x16x32_bf16 v[104:107], v[152:155], v[176:179], v[104:107]
    ds_read_b64_tr_b16 v[134:135], v61 offset:1024
    ds_read_b64_tr_b16 v[136:137], v62 offset:0
    v_mfma_f32_16x16x32_bf16 v[108:111], v[152:155], v[180:183], v[108:111]
    ds_read_b64_tr_b16 v[138:139], v62 offset:1024
    v_mfma_f32_16x16x32_bf16 v[120:123], v[156:159], v[176:179], v[120:123]
    ds_read_b64_tr_b16 v[140:141], v63 offset:0
    ds_read_b64_tr_b16 v[142:143], v63 offset:1024
    v_mfma_f32_16x16x32_bf16 v[124:127], v[156:159], v[180:183], v[124:127]
    buffer_load_dwordx4 v11, s[48:51], s40 offen offset:1024  lds
    s_waitcnt lgkmcnt(6)
    v_mfma_f32_16x16x32_bf16 v[64:67], v[128:131], v[160:163], v[64:67]
    ds_read_b64_tr_b16 v[144:145], v36 offset:0
    ds_read_b64_tr_b16 v[146:147], v36 offset:1024
    v_mfma_f32_16x16x32_bf16 v[68:71], v[128:131], v[164:167], v[68:71]
    ds_read_b64_tr_b16 v[148:149], v37 offset:0
    s_waitcnt lgkmcnt(7)
    v_mfma_f32_16x16x32_bf16 v[80:83], v[132:135], v[160:163], v[80:83]
    ds_read_b64_tr_b16 v[150:151], v37 offset:1024
    ds_read_b64_tr_b16 v[152:153], v38 offset:0
    v_mfma_f32_16x16x32_bf16 v[84:87], v[132:135], v[164:167], v[84:87]
    buffer_load_dwordx4 v12, s[48:51], s40 offen offset:2048  lds
    s_waitcnt lgkmcnt(7)
    v_mfma_f32_16x16x32_bf16 v[96:99], v[136:139], v[160:163], v[96:99]
    ds_read_b64_tr_b16 v[154:155], v38 offset:1024
    ds_read_b64_tr_b16 v[156:157], v39 offset:0
    v_mfma_f32_16x16x32_bf16 v[100:103], v[136:139], v[164:167], v[100:103]
    ds_read_b64_tr_b16 v[158:159], v39 offset:1024
    s_waitcnt lgkmcnt(8)
    v_mfma_f32_16x16x32_bf16 v[112:115], v[140:143], v[160:163], v[112:115]
    v_mfma_f32_16x16x32_bf16 v[116:119], v[140:143], v[164:167], v[116:119]
    buffer_load_dwordx4 v13, s[48:51], s40 offen offset:3072  lds
    s_waitcnt lgkmcnt(6)
    v_mfma_f32_16x16x32_bf16 v[72:75], v[144:147], v[160:163], v[72:75]
    ds_read_b128 v[176:179], v50 offset:0
    ds_read_b128 v[180:183], v50 offset:2048
    v_mfma_f32_16x16x32_bf16 v[76:79], v[144:147], v[164:167], v[76:79]
    ds_read_b64_tr_b16 v[128:129], v60 offset:8192
    s_waitcnt lgkmcnt(7)
    v_mfma_f32_16x16x32_bf16 v[88:91], v[148:151], v[160:163], v[88:91]
    ds_read_b64_tr_b16 v[130:131], v60 offset:9216
    ds_read_b64_tr_b16 v[132:133], v61 offset:8192
    v_mfma_f32_16x16x32_bf16 v[92:95], v[148:151], v[164:167], v[92:95]
    s_add_u32 m0, s43, 114688
    s_lshl_b32 s40, s39, 7
    buffer_load_dwordx4 v14, s[44:47], s40 offen offset:0  lds
    s_waitcnt lgkmcnt(7)
    v_mfma_f32_16x16x32_bf16 v[104:107], v[152:155], v[160:163], v[104:107]
    ds_read_b64_tr_b16 v[134:135], v61 offset:9216
    ds_read_b64_tr_b16 v[136:137], v62 offset:8192
    v_mfma_f32_16x16x32_bf16 v[108:111], v[152:155], v[164:167], v[108:111]
    ds_read_b64_tr_b16 v[138:139], v62 offset:9216
    s_waitcnt lgkmcnt(8)
    v_mfma_f32_16x16x32_bf16 v[120:123], v[156:159], v[160:163], v[120:123]
    ds_read_b64_tr_b16 v[140:141], v63 offset:8192
    ds_read_b64_tr_b16 v[142:143], v63 offset:9216
    v_mfma_f32_16x16x32_bf16 v[124:127], v[156:159], v[164:167], v[124:127]
    buffer_load_dwordx4 v15, s[44:47], s40 offen offset:1024  lds
    s_waitcnt lgkmcnt(6)
    v_mfma_f32_16x16x32_bf16 v[64:67], v[128:131], v[176:179], v[64:67]
    ds_read_b64_tr_b16 v[144:145], v36 offset:8192
    ds_read_b64_tr_b16 v[146:147], v36 offset:9216
    v_mfma_f32_16x16x32_bf16 v[68:71], v[128:131], v[180:183], v[68:71]
    ds_read_b64_tr_b16 v[148:149], v37 offset:8192
    s_waitcnt lgkmcnt(7)
    v_mfma_f32_16x16x32_bf16 v[80:83], v[132:135], v[176:179], v[80:83]
    ds_read_b64_tr_b16 v[150:151], v37 offset:9216
    ds_read_b64_tr_b16 v[152:153], v38 offset:8192
    v_mfma_f32_16x16x32_bf16 v[84:87], v[132:135], v[180:183], v[84:87]
    buffer_load_dwordx4 v16, s[44:47], s40 offen offset:2048  lds
    s_waitcnt lgkmcnt(7)
    v_mfma_f32_16x16x32_bf16 v[96:99], v[136:139], v[176:179], v[96:99]
    ds_read_b64_tr_b16 v[154:155], v38 offset:9216
    ds_read_b64_tr_b16 v[156:157], v39 offset:8192
    v_mfma_f32_16x16x32_bf16 v[100:103], v[136:139], v[180:183], v[100:103]
    ds_read_b64_tr_b16 v[158:159], v39 offset:9216
    s_waitcnt lgkmcnt(8)
    v_mfma_f32_16x16x32_bf16 v[112:115], v[140:143], v[176:179], v[112:115]
    v_mfma_f32_16x16x32_bf16 v[116:119], v[140:143], v[180:183], v[116:119]
    buffer_load_dwordx4 v17, s[44:47], s40 offen offset:3072  lds
    s_waitcnt vmcnt(25) lgkmcnt(0)
    s_barrier
    v_mfma_f32_16x16x32_bf16 v[72:75], v[144:147], v[176:179], v[72:75]
    ds_read_b128 v[160:163], v40 offset:0
    ds_read_b128 v[164:167], v40 offset:2048
    v_mfma_f32_16x16x32_bf16 v[76:79], v[144:147], v[180:183], v[76:79]
    ds_read_b64_tr_b16 v[128:129], v52 offset:0
    v_mfma_f32_16x16x32_bf16 v[88:91], v[148:151], v[176:179], v[88:91]
    ds_read_b64_tr_b16 v[130:131], v52 offset:1024
    ds_read_b64_tr_b16 v[132:133], v53 offset:0
    v_mfma_f32_16x16x32_bf16 v[92:95], v[148:151], v[180:183], v[92:95]
    s_add_u32 s39, s28, 14
    s_and_b32 s39, s39, 15
    s_add_u32 m0, s43, 131072
    s_lshl_b32 s40, s39, 19
    buffer_load_dwordx4 v10, s[48:51], s40 offen offset:0  lds
    v_mfma_f32_16x16x32_bf16 v[104:107], v[152:155], v[176:179], v[104:107]
    ds_read_b64_tr_b16 v[134:135], v53 offset:1024
    ds_read_b64_tr_b16 v[136:137], v54 offset:0
    v_mfma_f32_16x16x32_bf16 v[108:111], v[152:155], v[180:183], v[108:111]
    ds_read_b64_tr_b16 v[138:139], v54 offset:1024
    v_mfma_f32_16x16x32_bf16 v[120:123], v[156:159], v[176:179], v[120:123]
    ds_read_b64_tr_b16 v[140:141], v55 offset:0
    ds_read_b64_tr_b16 v[142:143], v55 offset:1024
    v_mfma_f32_16x16x32_bf16 v[124:127], v[156:159], v[180:183], v[124:127]
    buffer_load_dwordx4 v11, s[48:51], s40 offen offset:1024  lds
    s_waitcnt lgkmcnt(6)
    v_mfma_f32_16x16x32_bf16 v[64:67], v[128:131], v[160:163], v[64:67]
    ds_read_b64_tr_b16 v[144:145], v28 offset:0
    ds_read_b64_tr_b16 v[146:147], v28 offset:1024
    v_mfma_f32_16x16x32_bf16 v[68:71], v[128:131], v[164:167], v[68:71]
    ds_read_b64_tr_b16 v[148:149], v29 offset:0
    s_waitcnt lgkmcnt(7)
    v_mfma_f32_16x16x32_bf16 v[80:83], v[132:135], v[160:163], v[80:83]
    ds_read_b64_tr_b16 v[150:151], v29 offset:1024
    ds_read_b64_tr_b16 v[152:153], v30 offset:0
    v_mfma_f32_16x16x32_bf16 v[84:87], v[132:135], v[164:167], v[84:87]
    buffer_load_dwordx4 v12, s[48:51], s40 offen offset:2048  lds
    s_waitcnt lgkmcnt(7)
    v_mfma_f32_16x16x32_bf16 v[96:99], v[136:139], v[160:163], v[96:99]
    ds_read_b64_tr_b16 v[154:155], v30 offset:1024
    ds_read_b64_tr_b16 v[156:157], v31 offset:0
    v_mfma_f32_16x16x32_bf16 v[100:103], v[136:139], v[164:167], v[100:103]
    ds_read_b64_tr_b16 v[158:159], v31 offset:1024
    s_waitcnt lgkmcnt(8)
    v_mfma_f32_16x16x32_bf16 v[112:115], v[140:143], v[160:163], v[112:115]
    v_mfma_f32_16x16x32_bf16 v[116:119], v[140:143], v[164:167], v[116:119]
    buffer_load_dwordx4 v13, s[48:51], s40 offen offset:3072  lds
    s_waitcnt lgkmcnt(6)
    v_mfma_f32_16x16x32_bf16 v[72:75], v[144:147], v[160:163], v[72:75]
    ds_read_b128 v[176:179], v42 offset:0
    ds_read_b128 v[180:183], v42 offset:2048
    v_mfma_f32_16x16x32_bf16 v[76:79], v[144:147], v[164:167], v[76:79]
    ds_read_b64_tr_b16 v[128:129], v52 offset:8192
    s_waitcnt lgkmcnt(7)
    v_mfma_f32_16x16x32_bf16 v[88:91], v[148:151], v[160:163], v[88:91]
    ds_read_b64_tr_b16 v[130:131], v52 offset:9216
    ds_read_b64_tr_b16 v[132:133], v53 offset:8192
    v_mfma_f32_16x16x32_bf16 v[92:95], v[148:151], v[164:167], v[92:95]
    s_add_u32 m0, s43, 147456
    s_lshl_b32 s40, s39, 7
    buffer_load_dwordx4 v14, s[44:47], s40 offen offset:0  lds
    s_waitcnt lgkmcnt(7)
    v_mfma_f32_16x16x32_bf16 v[104:107], v[152:155], v[160:163], v[104:107]
    ds_read_b64_tr_b16 v[134:135], v53 offset:9216
    ds_read_b64_tr_b16 v[136:137], v54 offset:8192
    v_mfma_f32_16x16x32_bf16 v[108:111], v[152:155], v[164:167], v[108:111]
    ds_read_b64_tr_b16 v[138:139], v54 offset:9216
    s_waitcnt lgkmcnt(8)
    v_mfma_f32_16x16x32_bf16 v[120:123], v[156:159], v[160:163], v[120:123]
    ds_read_b64_tr_b16 v[140:141], v55 offset:8192
    ds_read_b64_tr_b16 v[142:143], v55 offset:9216
    v_mfma_f32_16x16x32_bf16 v[124:127], v[156:159], v[164:167], v[124:127]
    buffer_load_dwordx4 v15, s[44:47], s40 offen offset:1024  lds
    s_waitcnt lgkmcnt(6)
    v_mfma_f32_16x16x32_bf16 v[64:67], v[128:131], v[176:179], v[64:67]
    ds_read_b64_tr_b16 v[144:145], v28 offset:8192
    ds_read_b64_tr_b16 v[146:147], v28 offset:9216
    v_mfma_f32_16x16x32_bf16 v[68:71], v[128:131], v[180:183], v[68:71]
    ds_read_b64_tr_b16 v[148:149], v29 offset:8192
    s_waitcnt lgkmcnt(7)
    v_mfma_f32_16x16x32_bf16 v[80:83], v[132:135], v[176:179], v[80:83]
    ds_read_b64_tr_b16 v[150:151], v29 offset:9216
    ds_read_b64_tr_b16 v[152:153], v30 offset:8192
    v_mfma_f32_16x16x32_bf16 v[84:87], v[132:135], v[180:183], v[84:87]
    buffer_load_dwordx4 v16, s[44:47], s40 offen offset:2048  lds
    s_waitcnt lgkmcnt(7)
    v_mfma_f32_16x16x32_bf16 v[96:99], v[136:139], v[176:179], v[96:99]
    ds_read_b64_tr_b16 v[154:155], v30 offset:9216
    ds_read_b64_tr_b16 v[156:157], v31 offset:8192
    v_mfma_f32_16x16x32_bf16 v[100:103], v[136:139], v[180:183], v[100:103]
    ds_read_b64_tr_b16 v[158:159], v31 offset:9216
    s_waitcnt lgkmcnt(8)
    v_mfma_f32_16x16x32_bf16 v[112:115], v[140:143], v[176:179], v[112:115]
    v_mfma_f32_16x16x32_bf16 v[116:119], v[140:143], v[180:183], v[116:119]
    buffer_load_dwordx4 v17, s[44:47], s40 offen offset:3072  lds
    s_waitcnt vmcnt(25) lgkmcnt(0)
    s_barrier
    v_mfma_f32_16x16x32_bf16 v[72:75], v[144:147], v[176:179], v[72:75]
    ds_read_b128 v[160:163], v40 offset:32768
    ds_read_b128 v[164:167], v40 offset:34816
    v_mfma_f32_16x16x32_bf16 v[76:79], v[144:147], v[180:183], v[76:79]
    ds_read_b64_tr_b16 v[128:129], v52 offset:32768
    v_mfma_f32_16x16x32_bf16 v[88:91], v[148:151], v[176:179], v[88:91]
    ds_read_b64_tr_b16 v[130:131], v52 offset:33792
    ds_read_b64_tr_b16 v[132:133], v53 offset:32768
    v_mfma_f32_16x16x32_bf16 v[92:95], v[148:151], v[180:183], v[92:95]
    s_add_u32 s39, s28, 15
    s_and_b32 s39, s39, 15
    s_add_u32 m0, s43, 0
    s_lshl_b32 s40, s39, 19
    buffer_load_dwordx4 v10, s[48:51], s40 offen offset:0  lds
    v_mfma_f32_16x16x32_bf16 v[104:107], v[152:155], v[176:179], v[104:107]
    ds_read_b64_tr_b16 v[134:135], v53 offset:33792
    ds_read_b64_tr_b16 v[136:137], v54 offset:32768
    v_mfma_f32_16x16x32_bf16 v[108:111], v[152:155], v[180:183], v[108:111]
    ds_read_b64_tr_b16 v[138:139], v54 offset:33792
    v_mfma_f32_16x16x32_bf16 v[120:123], v[156:159], v[176:179], v[120:123]
    ds_read_b64_tr_b16 v[140:141], v55 offset:32768
    ds_read_b64_tr_b16 v[142:143], v55 offset:33792
    v_mfma_f32_16x16x32_bf16 v[124:127], v[156:159], v[180:183], v[124:127]
    buffer_load_dwordx4 v11, s[48:51], s40 offen offset:1024  lds
    s_waitcnt lgkmcnt(6)
    v_mfma_f32_16x16x32_bf16 v[64:67], v[128:131], v[160:163], v[64:67]
    ds_read_b64_tr_b16 v[144:145], v28 offset:32768
    ds_read_b64_tr_b16 v[146:147], v28 offset:33792
    v_mfma_f32_16x16x32_bf16 v[68:71], v[128:131], v[164:167], v[68:71]
    ds_read_b64_tr_b16 v[148:149], v29 offset:32768
    s_waitcnt lgkmcnt(7)
    v_mfma_f32_16x16x32_bf16 v[80:83], v[132:135], v[160:163], v[80:83]
    ds_read_b64_tr_b16 v[150:151], v29 offset:33792
    ds_read_b64_tr_b16 v[152:153], v30 offset:32768
    v_mfma_f32_16x16x32_bf16 v[84:87], v[132:135], v[164:167], v[84:87]
    buffer_load_dwordx4 v12, s[48:51], s40 offen offset:2048  lds
    s_waitcnt lgkmcnt(7)
    v_mfma_f32_16x16x32_bf16 v[96:99], v[136:139], v[160:163], v[96:99]
    ds_read_b64_tr_b16 v[154:155], v30 offset:33792
    ds_read_b64_tr_b16 v[156:157], v31 offset:32768
    v_mfma_f32_16x16x32_bf16 v[100:103], v[136:139], v[164:167], v[100:103]
    ds_read_b64_tr_b16 v[158:159], v31 offset:33792
    s_waitcnt lgkmcnt(8)
    v_mfma_f32_16x16x32_bf16 v[112:115], v[140:143], v[160:163], v[112:115]
    v_mfma_f32_16x16x32_bf16 v[116:119], v[140:143], v[164:167], v[116:119]
    buffer_load_dwordx4 v13, s[48:51], s40 offen offset:3072  lds
    s_waitcnt lgkmcnt(6)
    v_mfma_f32_16x16x32_bf16 v[72:75], v[144:147], v[160:163], v[72:75]
    ds_read_b128 v[176:179], v42 offset:32768
    ds_read_b128 v[180:183], v42 offset:34816
    v_mfma_f32_16x16x32_bf16 v[76:79], v[144:147], v[164:167], v[76:79]
    ds_read_b64_tr_b16 v[128:129], v52 offset:40960
    s_waitcnt lgkmcnt(7)
    v_mfma_f32_16x16x32_bf16 v[88:91], v[148:151], v[160:163], v[88:91]
    ds_read_b64_tr_b16 v[130:131], v52 offset:41984
    ds_read_b64_tr_b16 v[132:133], v53 offset:40960
    v_mfma_f32_16x16x32_bf16 v[92:95], v[148:151], v[164:167], v[92:95]
    s_add_u32 m0, s43, 16384
    s_lshl_b32 s40, s39, 7
    buffer_load_dwordx4 v14, s[44:47], s40 offen offset:0  lds
    s_waitcnt lgkmcnt(7)
    v_mfma_f32_16x16x32_bf16 v[104:107], v[152:155], v[160:163], v[104:107]
    ds_read_b64_tr_b16 v[134:135], v53 offset:41984
    ds_read_b64_tr_b16 v[136:137], v54 offset:40960
    v_mfma_f32_16x16x32_bf16 v[108:111], v[152:155], v[164:167], v[108:111]
    ds_read_b64_tr_b16 v[138:139], v54 offset:41984
    s_waitcnt lgkmcnt(8)
    v_mfma_f32_16x16x32_bf16 v[120:123], v[156:159], v[160:163], v[120:123]
    ds_read_b64_tr_b16 v[140:141], v55 offset:40960
    ds_read_b64_tr_b16 v[142:143], v55 offset:41984
    v_mfma_f32_16x16x32_bf16 v[124:127], v[156:159], v[164:167], v[124:127]
    buffer_load_dwordx4 v15, s[44:47], s40 offen offset:1024  lds
    s_waitcnt lgkmcnt(6)
    v_mfma_f32_16x16x32_bf16 v[64:67], v[128:131], v[176:179], v[64:67]
    ds_read_b64_tr_b16 v[144:145], v28 offset:40960
    ds_read_b64_tr_b16 v[146:147], v28 offset:41984
    v_mfma_f32_16x16x32_bf16 v[68:71], v[128:131], v[180:183], v[68:71]
    ds_read_b64_tr_b16 v[148:149], v29 offset:40960
    s_waitcnt lgkmcnt(7)
    v_mfma_f32_16x16x32_bf16 v[80:83], v[132:135], v[176:179], v[80:83]
    ds_read_b64_tr_b16 v[150:151], v29 offset:41984
    ds_read_b64_tr_b16 v[152:153], v30 offset:40960
    v_mfma_f32_16x16x32_bf16 v[84:87], v[132:135], v[180:183], v[84:87]
    buffer_load_dwordx4 v16, s[44:47], s40 offen offset:2048  lds
    s_waitcnt lgkmcnt(7)
    v_mfma_f32_16x16x32_bf16 v[96:99], v[136:139], v[176:179], v[96:99]
    ds_read_b64_tr_b16 v[154:155], v30 offset:41984
    ds_read_b64_tr_b16 v[156:157], v31 offset:40960
    v_mfma_f32_16x16x32_bf16 v[100:103], v[136:139], v[180:183], v[100:103]
    ds_read_b64_tr_b16 v[158:159], v31 offset:41984
    s_waitcnt lgkmcnt(8)
    v_mfma_f32_16x16x32_bf16 v[112:115], v[140:143], v[176:179], v[112:115]
    v_mfma_f32_16x16x32_bf16 v[116:119], v[140:143], v[180:183], v[116:119]
    buffer_load_dwordx4 v17, s[44:47], s40 offen offset:3072  lds
    s_waitcnt vmcnt(25) lgkmcnt(0)
    s_barrier
    v_mfma_f32_16x16x32_bf16 v[72:75], v[144:147], v[176:179], v[72:75]
    ds_read_b128 v[160:163], v44 offset:0
    ds_read_b128 v[164:167], v44 offset:2048
    v_mfma_f32_16x16x32_bf16 v[76:79], v[144:147], v[180:183], v[76:79]
    ds_read_b64_tr_b16 v[128:129], v56 offset:0
    v_mfma_f32_16x16x32_bf16 v[88:91], v[148:151], v[176:179], v[88:91]
    ds_read_b64_tr_b16 v[130:131], v56 offset:1024
    ds_read_b64_tr_b16 v[132:133], v57 offset:0
    v_mfma_f32_16x16x32_bf16 v[92:95], v[148:151], v[180:183], v[92:95]
    s_add_u32 m0, s68, 32768
    s_add_u32 s40, s31, 0
    buffer_load_dwordx4 v22, s[52:55], s40 offen offset:0  lds
    v_mfma_f32_16x16x32_bf16 v[104:107], v[152:155], v[176:179], v[104:107]
    ds_read_b64_tr_b16 v[134:135], v57 offset:1024
    ds_read_b64_tr_b16 v[136:137], v58 offset:0
    v_mfma_f32_16x16x32_bf16 v[108:111], v[152:155], v[180:183], v[108:111]
    ds_read_b64_tr_b16 v[138:139], v58 offset:1024
    v_mfma_f32_16x16x32_bf16 v[120:123], v[156:159], v[176:179], v[120:123]
    ds_read_b64_tr_b16 v[140:141], v59 offset:0
    ds_read_b64_tr_b16 v[142:143], v59 offset:1024
    v_mfma_f32_16x16x32_bf16 v[124:127], v[156:159], v[180:183], v[124:127]
    buffer_load_dwordx4 v23, s[52:55], s40 offen offset:1024  lds
    s_waitcnt lgkmcnt(6)
    v_mfma_f32_16x16x32_bf16 v[64:67], v[128:131], v[160:163], v[64:67]
    ds_read_b64_tr_b16 v[144:145], v32 offset:0
    ds_read_b64_tr_b16 v[146:147], v32 offset:1024
    v_mfma_f32_16x16x32_bf16 v[68:71], v[128:131], v[164:167], v[68:71]
    ds_read_b64_tr_b16 v[148:149], v33 offset:0
    s_waitcnt lgkmcnt(7)
    v_mfma_f32_16x16x32_bf16 v[80:83], v[132:135], v[160:163], v[80:83]
    ds_read_b64_tr_b16 v[150:151], v33 offset:1024
    ds_read_b64_tr_b16 v[152:153], v34 offset:0
    v_mfma_f32_16x16x32_bf16 v[84:87], v[132:135], v[164:167], v[84:87]
    buffer_load_dwordx4 v24, s[52:55], s40 offen offset:2048  lds
    s_waitcnt lgkmcnt(7)
    v_mfma_f32_16x16x32_bf16 v[96:99], v[136:139], v[160:163], v[96:99]
    ds_read_b64_tr_b16 v[154:155], v34 offset:1024
    ds_read_b64_tr_b16 v[156:157], v35 offset:0
    v_mfma_f32_16x16x32_bf16 v[100:103], v[136:139], v[164:167], v[100:103]
    ds_read_b64_tr_b16 v[158:159], v35 offset:1024
    s_waitcnt lgkmcnt(8)
    v_mfma_f32_16x16x32_bf16 v[112:115], v[140:143], v[160:163], v[112:115]
    v_mfma_f32_16x16x32_bf16 v[116:119], v[140:143], v[164:167], v[116:119]
    buffer_load_dwordx4 v25, s[52:55], s40 offen offset:3072  lds
    s_waitcnt lgkmcnt(6)
    v_mfma_f32_16x16x32_bf16 v[72:75], v[144:147], v[160:163], v[72:75]
    ds_read_b128 v[176:179], v46 offset:0
    ds_read_b128 v[180:183], v46 offset:2048
    v_mfma_f32_16x16x32_bf16 v[76:79], v[144:147], v[164:167], v[76:79]
    ds_read_b64_tr_b16 v[128:129], v56 offset:8192
    s_waitcnt lgkmcnt(7)
    v_mfma_f32_16x16x32_bf16 v[88:91], v[148:151], v[160:163], v[88:91]
    ds_read_b64_tr_b16 v[130:131], v56 offset:9216
    ds_read_b64_tr_b16 v[132:133], v57 offset:8192
    v_mfma_f32_16x16x32_bf16 v[92:95], v[148:151], v[164:167], v[92:95]
    s_add_u32 m0, s68, 36864
    s_add_u32 s40, s31, 4096
    buffer_load_dwordx4 v22, s[52:55], s40 offen offset:0  lds
    s_waitcnt lgkmcnt(7)
    v_mfma_f32_16x16x32_bf16 v[104:107], v[152:155], v[160:163], v[104:107]
    ds_read_b64_tr_b16 v[134:135], v57 offset:9216
    ds_read_b64_tr_b16 v[136:137], v58 offset:8192
    v_mfma_f32_16x16x32_bf16 v[108:111], v[152:155], v[164:167], v[108:111]
    ds_read_b64_tr_b16 v[138:139], v58 offset:9216
    s_waitcnt lgkmcnt(8)
    v_mfma_f32_16x16x32_bf16 v[120:123], v[156:159], v[160:163], v[120:123]
    ds_read_b64_tr_b16 v[140:141], v59 offset:8192
    ds_read_b64_tr_b16 v[142:143], v59 offset:9216
    v_mfma_f32_16x16x32_bf16 v[124:127], v[156:159], v[164:167], v[124:127]
    buffer_load_dwordx4 v23, s[52:55], s40 offen offset:1024  lds
    s_waitcnt lgkmcnt(6)
    v_mfma_f32_16x16x32_bf16 v[64:67], v[128:131], v[176:179], v[64:67]
    ds_read_b64_tr_b16 v[144:145], v32 offset:8192
    ds_read_b64_tr_b16 v[146:147], v32 offset:9216
    v_mfma_f32_16x16x32_bf16 v[68:71], v[128:131], v[180:183], v[68:71]
    ds_read_b64_tr_b16 v[148:149], v33 offset:8192
    s_waitcnt lgkmcnt(7)
    v_mfma_f32_16x16x32_bf16 v[80:83], v[132:135], v[176:179], v[80:83]
    ds_read_b64_tr_b16 v[150:151], v33 offset:9216
    ds_read_b64_tr_b16 v[152:153], v34 offset:8192
    v_mfma_f32_16x16x32_bf16 v[84:87], v[132:135], v[180:183], v[84:87]
    buffer_load_dwordx4 v24, s[52:55], s40 offen offset:2048  lds
    s_waitcnt lgkmcnt(7)
    v_mfma_f32_16x16x32_bf16 v[96:99], v[136:139], v[176:179], v[96:99]
    ds_read_b64_tr_b16 v[154:155], v34 offset:9216
    ds_read_b64_tr_b16 v[156:157], v35 offset:8192
    v_mfma_f32_16x16x32_bf16 v[100:103], v[136:139], v[180:183], v[100:103]
    ds_read_b64_tr_b16 v[158:159], v35 offset:9216
    s_waitcnt lgkmcnt(8)
    v_mfma_f32_16x16x32_bf16 v[112:115], v[140:143], v[176:179], v[112:115]
    v_mfma_f32_16x16x32_bf16 v[116:119], v[140:143], v[180:183], v[116:119]
    buffer_load_dwordx4 v25, s[52:55], s40 offen offset:3072  lds
    s_waitcnt vmcnt(24) lgkmcnt(0)
    s_barrier
    v_xor_b32 v14, 32, v18
    v_xor_b32 v15, 32, v19
    v_xor_b32 v16, 32, v20
    v_xor_b32 v17, 32, v21
    v_mfma_f32_16x16x32_bf16 v[72:75], v[144:147], v[176:179], v[72:75]
    ds_read_b128 v[160:163], v44 offset:32768
    ds_read_b128 v[164:167], v44 offset:34816
    v_mfma_f32_16x16x32_bf16 v[76:79], v[144:147], v[180:183], v[76:79]
    ds_read_b64_tr_b16 v[128:129], v56 offset:32768
    v_mfma_f32_16x16x32_bf16 v[88:91], v[148:151], v[176:179], v[88:91]
    ds_read_b64_tr_b16 v[130:131], v56 offset:33792
    ds_read_b64_tr_b16 v[132:133], v57 offset:32768
    v_mfma_f32_16x16x32_bf16 v[92:95], v[148:151], v[180:183], v[92:95]
    s_add_u32 m0, s68, 65536
    s_add_u32 s40, s31, 0
    buffer_load_dwordx4 v26, s[56:59], s40 offen offset:0  lds
    v_mfma_f32_16x16x32_bf16 v[104:107], v[152:155], v[176:179], v[104:107]
    ds_read_b64_tr_b16 v[134:135], v57 offset:33792
    ds_read_b64_tr_b16 v[136:137], v58 offset:32768
    v_mfma_f32_16x16x32_bf16 v[108:111], v[152:155], v[180:183], v[108:111]
    ds_read_b64_tr_b16 v[138:139], v58 offset:33792
    v_mfma_f32_16x16x32_bf16 v[120:123], v[156:159], v[176:179], v[120:123]
    ds_read_b64_tr_b16 v[140:141], v59 offset:32768
    ds_read_b64_tr_b16 v[142:143], v59 offset:33792
    v_mfma_f32_16x16x32_bf16 v[124:127], v[156:159], v[180:183], v[124:127]
    buffer_load_dwordx4 v26, s[56:59], s40 offen offset:1024  lds
    s_waitcnt lgkmcnt(6)
    v_mfma_f32_16x16x32_bf16 v[64:67], v[128:131], v[160:163], v[64:67]
    ds_read_b64_tr_b16 v[144:145], v32 offset:32768
    ds_read_b64_tr_b16 v[146:147], v32 offset:33792
    v_mfma_f32_16x16x32_bf16 v[68:71], v[128:131], v[164:167], v[68:71]
    ds_read_b64_tr_b16 v[148:149], v33 offset:32768
    s_waitcnt lgkmcnt(7)
    v_mfma_f32_16x16x32_bf16 v[80:83], v[132:135], v[160:163], v[80:83]
    ds_read_b64_tr_b16 v[150:151], v33 offset:33792
    ds_read_b64_tr_b16 v[152:153], v34 offset:32768
    v_mfma_f32_16x16x32_bf16 v[84:87], v[132:135], v[164:167], v[84:87]
    buffer_load_dwordx4 v26, s[56:59], s40 offen offset:2048  lds
    s_waitcnt lgkmcnt(7)
    v_mfma_f32_16x16x32_bf16 v[96:99], v[136:139], v[160:163], v[96:99]
    ds_read_b64_tr_b16 v[154:155], v34 offset:33792
    ds_read_b64_tr_b16 v[156:157], v35 offset:32768
    v_mfma_f32_16x16x32_bf16 v[100:103], v[136:139], v[164:167], v[100:103]
    ds_read_b64_tr_b16 v[158:159], v35 offset:33792
    s_waitcnt lgkmcnt(8)
    v_mfma_f32_16x16x32_bf16 v[112:115], v[140:143], v[160:163], v[112:115]
    v_mfma_f32_16x16x32_bf16 v[116:119], v[140:143], v[164:167], v[116:119]
    buffer_load_dwordx4 v26, s[56:59], s40 offen offset:3072  lds
    s_waitcnt lgkmcnt(6)
    v_mfma_f32_16x16x32_bf16 v[72:75], v[144:147], v[160:163], v[72:75]
    ds_read_b128 v[176:179], v46 offset:32768
    ds_read_b128 v[180:183], v46 offset:34816
    v_mfma_f32_16x16x32_bf16 v[76:79], v[144:147], v[164:167], v[76:79]
    ds_read_b64_tr_b16 v[128:129], v56 offset:40960
    s_waitcnt lgkmcnt(7)
    v_mfma_f32_16x16x32_bf16 v[88:91], v[148:151], v[160:163], v[88:91]
    ds_read_b64_tr_b16 v[130:131], v56 offset:41984
    ds_read_b64_tr_b16 v[132:133], v57 offset:40960
    v_mfma_f32_16x16x32_bf16 v[92:95], v[148:151], v[164:167], v[92:95]
    s_add_u32 m0, s68, 69632
    s_add_u32 s40, s31, 4096
    buffer_load_dwordx4 v26, s[56:59], s40 offen offset:0  lds
    s_waitcnt lgkmcnt(7)
    v_mfma_f32_16x16x32_bf16 v[104:107], v[152:155], v[160:163], v[104:107]
    ds_read_b64_tr_b16 v[134:135], v57 offset:41984
    ds_read_b64_tr_b16 v[136:137], v58 offset:40960
    v_mfma_f32_16x16x32_bf16 v[108:111], v[152:155], v[164:167], v[108:111]
    ds_read_b64_tr_b16 v[138:139], v58 offset:41984
    s_waitcnt lgkmcnt(8)
    v_mfma_f32_16x16x32_bf16 v[120:123], v[156:159], v[160:163], v[120:123]
    ds_read_b64_tr_b16 v[140:141], v59 offset:40960
    ds_read_b64_tr_b16 v[142:143], v59 offset:41984
    v_mfma_f32_16x16x32_bf16 v[124:127], v[156:159], v[164:167], v[124:127]
    buffer_load_dwordx4 v26, s[56:59], s40 offen offset:1024  lds
    s_waitcnt lgkmcnt(6)
    v_mfma_f32_16x16x32_bf16 v[64:67], v[128:131], v[176:179], v[64:67]
    ds_read_b64_tr_b16 v[144:145], v32 offset:40960
    ds_read_b64_tr_b16 v[146:147], v32 offset:41984
    v_mfma_f32_16x16x32_bf16 v[68:71], v[128:131], v[180:183], v[68:71]
    ds_read_b64_tr_b16 v[148:149], v33 offset:40960
    s_waitcnt lgkmcnt(7)
    v_mfma_f32_16x16x32_bf16 v[80:83], v[132:135], v[176:179], v[80:83]
    ds_read_b64_tr_b16 v[150:151], v33 offset:41984
    ds_read_b64_tr_b16 v[152:153], v34 offset:40960
    v_mfma_f32_16x16x32_bf16 v[84:87], v[132:135], v[180:183], v[84:87]
    buffer_load_dwordx4 v26, s[56:59], s40 offen offset:2048  lds
    s_waitcnt lgkmcnt(7)
    v_mfma_f32_16x16x32_bf16 v[96:99], v[136:139], v[176:179], v[96:99]
    ds_read_b64_tr_b16 v[154:155], v34 offset:41984
    ds_read_b64_tr_b16 v[156:157], v35 offset:40960
    v_mfma_f32_16x16x32_bf16 v[100:103], v[136:139], v[180:183], v[100:103]
    ds_read_b64_tr_b16 v[158:159], v35 offset:41984
    s_waitcnt lgkmcnt(8)
    v_mfma_f32_16x16x32_bf16 v[112:115], v[140:143], v[176:179], v[112:115]
    v_mfma_f32_16x16x32_bf16 v[116:119], v[140:143], v[180:183], v[116:119]
    buffer_load_dwordx4 v26, s[56:59], s40 offen offset:3072  lds
    s_waitcnt vmcnt(24) lgkmcnt(0)
    s_barrier
    buffer_load_dword v6, v4, s[64:67], 0 offen sc1
    buffer_load_dword v9, v8, s[64:67], s14 offen
    v_mfma_f32_16x16x32_bf16 v[72:75], v[144:147], v[176:179], v[72:75]
    ds_read_b128 v[160:163], v48 offset:0
    ds_read_b128 v[164:167], v48 offset:2048
    v_mfma_f32_16x16x32_bf16 v[76:79], v[144:147], v[180:183], v[76:79]
    ds_read_b64_tr_b16 v[128:129], v60 offset:0
    v_mfma_f32_16x16x32_bf16 v[88:91], v[148:151], v[176:179], v[88:91]
    ds_read_b64_tr_b16 v[130:131], v60 offset:1024
    ds_read_b64_tr_b16 v[132:133], v61 offset:0
    v_mfma_f32_16x16x32_bf16 v[92:95], v[148:151], v[180:183], v[92:95]
    s_bfe_u32 s39, s29, 0x30000
    s_add_u32 m0, s68, 98304
    s_lshl_b32 s40, s39, 18
    buffer_load_dwordx4 v18, s[60:63], s40 offen offset:0  lds
    v_mfma_f32_16x16x32_bf16 v[104:107], v[152:155], v[176:179], v[104:107]
    ds_read_b64_tr_b16 v[134:135], v61 offset:1024
    ds_read_b64_tr_b16 v[136:137], v62 offset:0
    v_mfma_f32_16x16x32_bf16 v[108:111], v[152:155], v[180:183], v[108:111]
    ds_read_b64_tr_b16 v[138:139], v62 offset:1024
    v_mfma_f32_16x16x32_bf16 v[120:123], v[156:159], v[176:179], v[120:123]
    ds_read_b64_tr_b16 v[140:141], v63 offset:0
    ds_read_b64_tr_b16 v[142:143], v63 offset:1024
    v_mfma_f32_16x16x32_bf16 v[124:127], v[156:159], v[180:183], v[124:127]
    buffer_load_dwordx4 v19, s[60:63], s40 offen offset:1024  lds
    s_waitcnt lgkmcnt(6)
    v_mfma_f32_16x16x32_bf16 v[64:67], v[128:131], v[160:163], v[64:67]
    ds_read_b64_tr_b16 v[144:145], v36 offset:0
    ds_read_b64_tr_b16 v[146:147], v36 offset:1024
    v_mfma_f32_16x16x32_bf16 v[68:71], v[128:131], v[164:167], v[68:71]
    ds_read_b64_tr_b16 v[148:149], v37 offset:0
    s_waitcnt lgkmcnt(7)
    v_mfma_f32_16x16x32_bf16 v[80:83], v[132:135], v[160:163], v[80:83]
    ds_read_b64_tr_b16 v[150:151], v37 offset:1024
    ds_read_b64_tr_b16 v[152:153], v38 offset:0
    v_mfma_f32_16x16x32_bf16 v[84:87], v[132:135], v[164:167], v[84:87]
    buffer_load_dwordx4 v20, s[60:63], s40 offen offset:2048  lds
    s_waitcnt lgkmcnt(7)
    v_mfma_f32_16x16x32_bf16 v[96:99], v[136:139], v[160:163], v[96:99]
    ds_read_b64_tr_b16 v[154:155], v38 offset:1024
    ds_read_b64_tr_b16 v[156:157], v39 offset:0
    v_mfma_f32_16x16x32_bf16 v[100:103], v[136:139], v[164:167], v[100:103]
    ds_read_b64_tr_b16 v[158:159], v39 offset:1024
    s_waitcnt lgkmcnt(8)
    v_mfma_f32_16x16x32_bf16 v[112:115], v[140:143], v[160:163], v[112:115]
    v_mfma_f32_16x16x32_bf16 v[116:119], v[140:143], v[164:167], v[116:119]
    buffer_load_dwordx4 v21, s[60:63], s40 offen offset:3072  lds
    s_waitcnt lgkmcnt(6)
    v_mfma_f32_16x16x32_bf16 v[72:75], v[144:147], v[160:163], v[72:75]
    ds_read_b128 v[176:179], v50 offset:0
    ds_read_b128 v[180:183], v50 offset:2048
    v_mfma_f32_16x16x32_bf16 v[76:79], v[144:147], v[164:167], v[76:79]
    ds_read_b64_tr_b16 v[128:129], v60 offset:8192
    s_waitcnt lgkmcnt(7)
    v_mfma_f32_16x16x32_bf16 v[88:91], v[148:151], v[160:163], v[88:91]
    ds_read_b64_tr_b16 v[130:131], v60 offset:9216
    ds_read_b64_tr_b16 v[132:133], v61 offset:8192
    v_mfma_f32_16x16x32_bf16 v[92:95], v[148:151], v[164:167], v[92:95]
    s_add_u32 m0, s68, 102400
    s_add_u32 s40, s40, 32768
    buffer_load_dwordx4 v14, s[60:63], s40 offen offset:0  lds
    s_waitcnt lgkmcnt(7)
    v_mfma_f32_16x16x32_bf16 v[104:107], v[152:155], v[160:163], v[104:107]
    ds_read_b64_tr_b16 v[134:135], v61 offset:9216
    ds_read_b64_tr_b16 v[136:137], v62 offset:8192
    v_mfma_f32_16x16x32_bf16 v[108:111], v[152:155], v[164:167], v[108:111]
    ds_read_b64_tr_b16 v[138:139], v62 offset:9216
    s_waitcnt lgkmcnt(8)
    v_mfma_f32_16x16x32_bf16 v[120:123], v[156:159], v[160:163], v[120:123]
    ds_read_b64_tr_b16 v[140:141], v63 offset:8192
    ds_read_b64_tr_b16 v[142:143], v63 offset:9216
    v_mfma_f32_16x16x32_bf16 v[124:127], v[156:159], v[164:167], v[124:127]
    buffer_load_dwordx4 v15, s[60:63], s40 offen offset:1024  lds
    s_waitcnt lgkmcnt(6)
    v_mfma_f32_16x16x32_bf16 v[64:67], v[128:131], v[176:179], v[64:67]
    ds_read_b64_tr_b16 v[144:145], v36 offset:8192
    ds_read_b64_tr_b16 v[146:147], v36 offset:9216
    v_mfma_f32_16x16x32_bf16 v[68:71], v[128:131], v[180:183], v[68:71]
    ds_read_b64_tr_b16 v[148:149], v37 offset:8192
    s_waitcnt lgkmcnt(7)
    v_mfma_f32_16x16x32_bf16 v[80:83], v[132:135], v[176:179], v[80:83]
    ds_read_b64_tr_b16 v[150:151], v37 offset:9216
    ds_read_b64_tr_b16 v[152:153], v38 offset:8192
    v_mfma_f32_16x16x32_bf16 v[84:87], v[132:135], v[180:183], v[84:87]
    buffer_load_dwordx4 v16, s[60:63], s40 offen offset:2048  lds
    s_waitcnt lgkmcnt(7)
    v_mfma_f32_16x16x32_bf16 v[96:99], v[136:139], v[176:179], v[96:99]
    ds_read_b64_tr_b16 v[154:155], v38 offset:9216
    ds_read_b64_tr_b16 v[156:157], v39 offset:8192
    v_mfma_f32_16x16x32_bf16 v[100:103], v[136:139], v[180:183], v[100:103]
    ds_read_b64_tr_b16 v[158:159], v39 offset:9216
    s_waitcnt lgkmcnt(8)
    v_mfma_f32_16x16x32_bf16 v[112:115], v[140:143], v[176:179], v[112:115]
    v_mfma_f32_16x16x32_bf16 v[116:119], v[140:143], v[180:183], v[116:119]
    buffer_load_dwordx4 v17, s[60:63], s40 offen offset:3072  lds
    s_waitcnt vmcnt(26) lgkmcnt(0)
    s_barrier
    v_mfma_f32_16x16x32_bf16 v[72:75], v[144:147], v[176:179], v[72:75]
    ds_read_b128 v[160:163], v40 offset:0
    ds_read_b128 v[164:167], v40 offset:2048
    v_mfma_f32_16x16x32_bf16 v[76:79], v[144:147], v[180:183], v[76:79]
    ds_read_b64_tr_b16 v[128:129], v52 offset:0
    v_mfma_f32_16x16x32_bf16 v[88:91], v[148:151], v[176:179], v[88:91]
    ds_read_b64_tr_b16 v[130:131], v52 offset:1024
    ds_read_b64_tr_b16 v[132:133], v53 offset:0
    v_mfma_f32_16x16x32_bf16 v[92:95], v[148:151], v[180:183], v[92:95]
    v_mfma_f32_16x16x32_bf16 v[104:107], v[152:155], v[176:179], v[104:107]
    ds_read_b64_tr_b16 v[134:135], v53 offset:1024
    ds_read_b64_tr_b16 v[136:137], v54 offset:0
    v_mfma_f32_16x16x32_bf16 v[108:111], v[152:155], v[180:183], v[108:111]
    ds_read_b64_tr_b16 v[138:139], v54 offset:1024
    v_mfma_f32_16x16x32_bf16 v[120:123], v[156:159], v[176:179], v[120:123]
    ds_read_b64_tr_b16 v[140:141], v55 offset:0
    ds_read_b64_tr_b16 v[142:143], v55 offset:1024
    v_mfma_f32_16x16x32_bf16 v[124:127], v[156:159], v[180:183], v[124:127]
    s_waitcnt lgkmcnt(6)
    v_mfma_f32_16x16x32_bf16 v[64:67], v[128:131], v[160:163], v[64:67]
    ds_read_b64_tr_b16 v[144:145], v28 offset:0
    ds_read_b64_tr_b16 v[146:147], v28 offset:1024
    v_mfma_f32_16x16x32_bf16 v[68:71], v[128:131], v[164:167], v[68:71]
    ds_read_b64_tr_b16 v[148:149], v29 offset:0
    s_waitcnt lgkmcnt(7)
    v_mfma_f32_16x16x32_bf16 v[80:83], v[132:135], v[160:163], v[80:83]
    ds_read_b64_tr_b16 v[150:151], v29 offset:1024
    ds_read_b64_tr_b16 v[152:153], v30 offset:0
    v_mfma_f32_16x16x32_bf16 v[84:87], v[132:135], v[164:167], v[84:87]
    s_waitcnt lgkmcnt(7)
    v_mfma_f32_16x16x32_bf16 v[96:99], v[136:139], v[160:163], v[96:99]
    ds_read_b64_tr_b16 v[154:155], v30 offset:1024
    ds_read_b64_tr_b16 v[156:157], v31 offset:0
    v_mfma_f32_16x16x32_bf16 v[100:103], v[136:139], v[164:167], v[100:103]
    ds_read_b64_tr_b16 v[158:159], v31 offset:1024
    s_waitcnt lgkmcnt(8)
    v_mfma_f32_16x16x32_bf16 v[112:115], v[140:143], v[160:163], v[112:115]
    v_mfma_f32_16x16x32_bf16 v[116:119], v[140:143], v[164:167], v[116:119]
    s_waitcnt lgkmcnt(6)
    v_mfma_f32_16x16x32_bf16 v[72:75], v[144:147], v[160:163], v[72:75]
    ds_read_b128 v[176:179], v42 offset:0
    ds_read_b128 v[180:183], v42 offset:2048
    v_mfma_f32_16x16x32_bf16 v[76:79], v[144:147], v[164:167], v[76:79]
    ds_read_b64_tr_b16 v[128:129], v52 offset:8192
    s_waitcnt lgkmcnt(7)
    v_mfma_f32_16x16x32_bf16 v[88:91], v[148:151], v[160:163], v[88:91]
    ds_read_b64_tr_b16 v[130:131], v52 offset:9216
    ds_read_b64_tr_b16 v[132:133], v53 offset:8192
    v_mfma_f32_16x16x32_bf16 v[92:95], v[148:151], v[164:167], v[92:95]
    s_waitcnt lgkmcnt(7)
    v_mfma_f32_16x16x32_bf16 v[104:107], v[152:155], v[160:163], v[104:107]
    ds_read_b64_tr_b16 v[134:135], v53 offset:9216
    ds_read_b64_tr_b16 v[136:137], v54 offset:8192
    v_mfma_f32_16x16x32_bf16 v[108:111], v[152:155], v[164:167], v[108:111]
    ds_read_b64_tr_b16 v[138:139], v54 offset:9216
    s_waitcnt lgkmcnt(8)
    v_mfma_f32_16x16x32_bf16 v[120:123], v[156:159], v[160:163], v[120:123]
    ds_read_b64_tr_b16 v[140:141], v55 offset:8192
    ds_read_b64_tr_b16 v[142:143], v55 offset:9216
    v_mfma_f32_16x16x32_bf16 v[124:127], v[156:159], v[164:167], v[124:127]
    s_waitcnt lgkmcnt(6)
    v_mfma_f32_16x16x32_bf16 v[64:67], v[128:131], v[176:179], v[64:67]
    ds_read_b64_tr_b16 v[144:145], v28 offset:8192
    ds_read_b64_tr_b16 v[146:147], v28 offset:9216
    v_mfma_f32_16x16x32_bf16 v[68:71], v[128:131], v[180:183], v[68:71]
    ds_read_b64_tr_b16 v[148:149], v29 offset:8192
    s_waitcnt lgkmcnt(7)
    v_mfma_f32_16x16x32_bf16 v[80:83], v[132:135], v[176:179], v[80:83]
    ds_read_b64_tr_b16 v[150:151], v29 offset:9216
    ds_read_b64_tr_b16 v[152:153], v30 offset:8192
    v_mfma_f32_16x16x32_bf16 v[84:87], v[132:135], v[180:183], v[84:87]
    s_waitcnt lgkmcnt(7)
    v_mfma_f32_16x16x32_bf16 v[96:99], v[136:139], v[176:179], v[96:99]
    ds_read_b64_tr_b16 v[154:155], v30 offset:9216
    ds_read_b64_tr_b16 v[156:157], v31 offset:8192
    v_mfma_f32_16x16x32_bf16 v[100:103], v[136:139], v[180:183], v[100:103]
    ds_read_b64_tr_b16 v[158:159], v31 offset:9216
    s_waitcnt lgkmcnt(8)
    v_mfma_f32_16x16x32_bf16 v[112:115], v[140:143], v[176:179], v[112:115]
    v_mfma_f32_16x16x32_bf16 v[116:119], v[140:143], v[180:183], v[116:119]
    s_waitcnt lgkmcnt(0)
    s_barrier
    v_mfma_f32_16x16x32_bf16 v[72:75], v[144:147], v[176:179], v[72:75]
    v_mfma_f32_16x16x32_bf16 v[76:79], v[144:147], v[180:183], v[76:79]
    v_mfma_f32_16x16x32_bf16 v[88:91], v[148:151], v[176:179], v[88:91]
    v_mfma_f32_16x16x32_bf16 v[92:95], v[148:151], v[180:183], v[92:95]
    v_mfma_f32_16x16x32_bf16 v[104:107], v[152:155], v[176:179], v[104:107]
    v_mfma_f32_16x16x32_bf16 v[108:111], v[152:155], v[180:183], v[108:111]
    v_mfma_f32_16x16x32_bf16 v[120:123], v[156:159], v[176:179], v[120:123]
    v_mfma_f32_16x16x32_bf16 v[124:127], v[156:159], v[180:183], v[124:127]
    v_lshrrev_b32 v5, 1, v2
    v_xor_b32 v5, v5, v2
    v_and_b32 v5, 1, v5
    v_mul_u32_u24 v5, 0x1800, v5
    s_lshl_b32 s39, s33, 6
    v_or_b32 v5, s39, v5
    v_xor_b32 v28, v5, v28
    v_xor_b32 v52, v5, v52
    v_xor_b32 v29, v5, v29
    v_xor_b32 v53, v5, v53
    v_xor_b32 v30, v5, v30
    v_xor_b32 v54, v5, v54
    v_xor_b32 v31, v5, v31
    v_xor_b32 v55, v5, v55
    v_xor_b32 v32, v5, v32
    v_xor_b32 v56, v5, v56
    v_xor_b32 v33, v5, v33
    v_xor_b32 v57, v5, v57
    v_xor_b32 v34, v5, v34
    v_xor_b32 v58, v5, v58
    v_xor_b32 v35, v5, v35
    v_xor_b32 v59, v5, v59
    v_xor_b32 v36, v5, v36
    v_xor_b32 v60, v5, v60
    v_xor_b32 v37, v5, v37
    v_xor_b32 v61, v5, v61
    v_xor_b32 v38, v5, v38
    v_xor_b32 v62, v5, v62
    v_xor_b32 v39, v5, v39
    v_xor_b32 v63, v5, v63
    v_and_b32 v5, 31, v0
    v_lshrrev_b32 v7, 5, v0
    v_xor_b32 v7, v7, v3
    v_lshlrev_b32 v7, 4, v7
    v_lshl_add_u32 v7, v5, 8, v7
    v_add_u32 v7, s68, v7
    s_waitcnt vmcnt(18)
    v_xor_b32 v5, 0, v7
    ds_read_b128 v[200:203], v5 offset:32768
    v_xor_b32 v5, 32, v7
    ds_read_b128 v[204:207], v5 offset:32768
    v_xor_b32 v5, 64, v7
    ds_read_b128 v[208:211], v5 offset:32768
    v_xor_b32 v5, 96, v7
    ds_read_b128 v[212:215], v5 offset:32768
    v_xor_b32 v5, 128, v7
    ds_read_b128 v[216:219], v5 offset:32768
    v_xor_b32 v5, 160, v7
    ds_read_b128 v[220:223], v5 offset:32768
    v_xor_b32 v5, 192, v7
    ds_read_b128 v[224:227], v5 offset:32768
    v_xor_b32 v5, 224, v7
    ds_read_b128 v[228:231], v5 offset:32768
    v_cvt_pk_bf16_f32 v168, v64, v65
    v_cvt_pk_bf16_f32 v169, v66, v67
    v_cvt_pk_bf16_f32 v170, v68, v69
    v_cvt_pk_bf16_f32 v171, v70, v71
    s_nop 1
    v_permlane16_swap_b32 v168, v170
    v_permlane16_swap_b32 v169, v171
    v_cvt_pk_bf16_f32 v172, v72, v73
    v_cvt_pk_bf16_f32 v173, v74, v75
    v_cvt_pk_bf16_f32 v174, v76, v77
    v_cvt_pk_bf16_f32 v175, v78, v79
    s_nop 1
    v_permlane16_swap_b32 v172, v174
    v_permlane16_swap_b32 v173, v175
    s_waitcnt lgkmcnt(7)
    v_mfma_f32_32x32x16_bf16 v[232:247], v[200:203], v[168:171], 0
    s_bfe_u32 s39, s29, 0x30004
    s_add_u32 m0, s68, 131072
    s_lshl_b32 s40, s39, 18
    buffer_load_dwordx4 v18, s[60:63], s40 offen offset:0  lds
    v_cvt_pk_bf16_f32 v176, v80, v81
    v_cvt_pk_bf16_f32 v177, v82, v83
    v_cvt_pk_bf16_f32 v178, v84, v85
    v_cvt_pk_bf16_f32 v179, v86, v87
    s_nop 1
    v_permlane16_swap_b32 v176, v178
    v_permlane16_swap_b32 v177, v179
    s_waitcnt lgkmcnt(6)
    v_mfma_f32_32x32x16_bf16 v[232:247], v[204:207], v[172:175], v[232:247]
    buffer_load_dwordx4 v19, s[60:63], s40 offen offset:1024  lds
    v_cvt_pk_bf16_f32 v180, v88, v89
    v_cvt_pk_bf16_f32 v181, v90, v91
    v_cvt_pk_bf16_f32 v182, v92, v93
    v_cvt_pk_bf16_f32 v183, v94, v95
    s_nop 1
    v_permlane16_swap_b32 v180, v182
    v_permlane16_swap_b32 v181, v183
    s_waitcnt lgkmcnt(5)
    v_mfma_f32_32x32x16_bf16 v[232:247], v[208:211], v[176:179], v[232:247]
    buffer_load_dwordx4 v20, s[60:63], s40 offen offset:2048  lds
    v_cvt_pk_bf16_f32 v184, v96, v97
    v_cvt_pk_bf16_f32 v185, v98, v99
    v_cvt_pk_bf16_f32 v186, v100, v101
    v_cvt_pk_bf16_f32 v187, v102, v103
    s_nop 1
    v_permlane16_swap_b32 v184, v186
    v_permlane16_swap_b32 v185, v187
    s_waitcnt lgkmcnt(4)
    v_mfma_f32_32x32x16_bf16 v[232:247], v[212:215], v[180:183], v[232:247]
    buffer_load_dwordx4 v21, s[60:63], s40 offen offset:3072  lds
    v_cvt_pk_bf16_f32 v188, v104, v105
    v_cvt_pk_bf16_f32 v189, v106, v107
    v_cvt_pk_bf16_f32 v190, v108, v109
    v_cvt_pk_bf16_f32 v191, v110, v111
    s_nop 1
    v_permlane16_swap_b32 v188, v190
    v_permlane16_swap_b32 v189, v191
    s_waitcnt lgkmcnt(3)
    v_mfma_f32_32x32x16_bf16 v[232:247], v[216:219], v[184:187], v[232:247]
    s_add_u32 m0, s68, 135168
    s_add_u32 s40, s40, 32768
    buffer_load_dwordx4 v14, s[60:63], s40 offen offset:0  lds
    v_cvt_pk_bf16_f32 v192, v112, v113
    v_cvt_pk_bf16_f32 v193, v114, v115
    v_cvt_pk_bf16_f32 v194, v116, v117
    v_cvt_pk_bf16_f32 v195, v118, v119
    s_nop 1
    v_permlane16_swap_b32 v192, v194
    v_permlane16_swap_b32 v193, v195
    s_waitcnt lgkmcnt(2)
    v_mfma_f32_32x32x16_bf16 v[232:247], v[220:223], v[188:191], v[232:247]
    buffer_load_dwordx4 v15, s[60:63], s40 offen offset:1024  lds
    v_cvt_pk_bf16_f32 v196, v120, v121
    v_cvt_pk_bf16_f32 v197, v122, v123
    v_cvt_pk_bf16_f32 v198, v124, v125
    v_cvt_pk_bf16_f32 v199, v126, v127
    s_nop 1
    v_permlane16_swap_b32 v196, v198
    v_permlane16_swap_b32 v197, v199
    s_waitcnt lgkmcnt(1)
    v_mfma_f32_32x32x16_bf16 v[232:247], v[224:227], v[192:195], v[232:247]
    buffer_load_dwordx4 v16, s[60:63], s40 offen offset:2048  lds
    v_add_u32 v27, s68, v27
    v_add_u32 v27, 65536, v27
    s_waitcnt lgkmcnt(0)
    v_mfma_f32_32x32x16_bf16 v[232:247], v[228:231], v[196:199], v[232:247]
    buffer_load_dwordx4 v17, s[60:63], s40 offen offset:3072  lds
    s_waitcnt vmcnt(18)
    v_xor_b32 v5, 0, v27
    ds_read_b64_tr_b16 v[128:129], v5 offset:0
    ds_read_b64_tr_b16 v[130:131], v5 offset:2048
    v_xor_b32 v5, 64, v27
    ds_read_b64_tr_b16 v[132:133], v5 offset:0
    ds_read_b64_tr_b16 v[134:135], v5 offset:2048
    v_xor_b32 v5, 128, v27
    ds_read_b64_tr_b16 v[136:137], v5 offset:0
    ds_read_b64_tr_b16 v[138:139], v5 offset:2048
    v_xor_b32 v5, 192, v27
    ds_read_b64_tr_b16 v[140:141], v5 offset:0
    ds_read_b64_tr_b16 v[142:143], v5 offset:2048
    s_waitcnt lgkmcnt(0)
    v_xor_b32 v5, 0, v27
    ds_read_b64_tr_b16 v[144:145], v5 offset:4096
    ds_read_b64_tr_b16 v[146:147], v5 offset:6144
    v_xor_b32 v5, 64, v27
    ds_read_b64_tr_b16 v[148:149], v5 offset:4096
    ds_read_b64_tr_b16 v[150:151], v5 offset:6144
    v_xor_b32 v5, 128, v27
    ds_read_b64_tr_b16 v[152:153], v5 offset:4096
    ds_read_b64_tr_b16 v[154:155], v5 offset:6144
    v_xor_b32 v5, 192, v27
    ds_read_b64_tr_b16 v[156:157], v5 offset:4096
    ds_read_b64_tr_b16 v[158:159], v5 offset:6144
    s_mov_b32 s42, 0x3e0293ee
    v_max3_f32 v5, v232, v233, v234
    v_max3_f32 v5, v5, v235, v236
    v_max3_f32 v5, v5, v237, v238
    v_max3_f32 v5, v5, v239, v240
    v_max3_f32 v5, v5, v241, v242
    v_max3_f32 v5, v5, v243, v244
    v_max3_f32 v5, v5, v245, v246
    v_max_f32 v5, v5, v247
    v_mov_b32 v7, v5
    s_nop 1
    v_permlane32_swap_b32 v5, v7
    v_max_f32 v5, v5, v7
    v_mul_f32 v5, s42, v5
    v_fma_f32 v232, v232, s42, -v5
    v_fma_f32 v233, v233, s42, -v5
    v_fma_f32 v234, v234, s42, -v5
    v_fma_f32 v235, v235, s42, -v5
    v_fma_f32 v236, v236, s42, -v5
    v_fma_f32 v237, v237, s42, -v5
    v_fma_f32 v238, v238, s42, -v5
    v_fma_f32 v239, v239, s42, -v5
    v_fma_f32 v240, v240, s42, -v5
    v_fma_f32 v241, v241, s42, -v5
    v_fma_f32 v242, v242, s42, -v5
    v_fma_f32 v243, v243, s42, -v5
    v_fma_f32 v244, v244, s42, -v5
    v_fma_f32 v245, v245, s42, -v5
    v_fma_f32 v246, v246, s42, -v5
    v_fma_f32 v247, v247, s42, -v5
    v_exp_f32 v232, v232
    v_exp_f32 v233, v233
    v_exp_f32 v234, v234
    v_exp_f32 v235, v235
    v_exp_f32 v236, v236
    v_exp_f32 v237, v237
    v_exp_f32 v238, v238
    v_exp_f32 v239, v239
    v_exp_f32 v240, v240
    v_exp_f32 v241, v241
    v_exp_f32 v242, v242
    v_exp_f32 v243, v243
    v_exp_f32 v244, v244
    v_exp_f32 v245, v245
    v_exp_f32 v246, v246
    v_exp_f32 v247, v247
    v_add_f32 v5, v232, v233
    v_add_f32 v7, v234, v235
    v_add_f32 v5, v5, v236
    v_add_f32 v7, v7, v237
    v_add_f32 v5, v5, v238
    v_add_f32 v7, v7, v239
    v_add_f32 v5, v5, v240
    v_add_f32 v7, v7, v241
    v_add_f32 v5, v5, v242
    v_add_f32 v7, v7, v243
    v_add_f32 v5, v5, v244
    v_add_f32 v7, v7, v245
    v_add_f32 v5, v5, v246
    v_add_f32 v7, v7, v247
    v_add_f32 v5, v5, v7
    v_mov_b32 v7, v5
    s_nop 1
    v_permlane32_swap_b32 v5, v7
    v_add_f32 v5, v5, v7
    v_rcp_f32 v5, v5
    s_nop 0
    v_mul_f32 v232, v232, v5
    v_mul_f32 v233, v233, v5
    v_mul_f32 v234, v234, v5
    v_mul_f32 v235, v235, v5
    v_mul_f32 v236, v236, v5
    v_mul_f32 v237, v237, v5
    v_mul_f32 v238, v238, v5
    v_mul_f32 v239, v239, v5
    v_mul_f32 v240, v240, v5
    v_mul_f32 v241, v241, v5
    v_mul_f32 v242, v242, v5
    v_mul_f32 v243, v243, v5
    v_mul_f32 v244, v244, v5
    v_mul_f32 v245, v245, v5
    v_mul_f32 v246, v246, v5
    v_mul_f32 v247, v247, v5
    v_cvt_pk_bf16_f32 v248, v232, v233
    v_cvt_pk_bf16_f32 v249, v234, v235
    v_cvt_pk_bf16_f32 v250, v236, v237
    v_cvt_pk_bf16_f32 v251, v238, v239
    v_cvt_pk_bf16_f32 v252, v240, v241
    v_cvt_pk_bf16_f32 v253, v242, v243
    v_cvt_pk_bf16_f32 v254, v244, v245
    v_cvt_pk_bf16_f32 v255, v246, v247
    s_nop 0
    s_waitcnt lgkmcnt(0)
    v_mfma_f32_32x32x16_bf16 v[64:79], v[128:131], v[248:251], 0
    v_mfma_f32_32x32x16_bf16 v[64:79], v[144:147], v[252:255], v[64:79]
    v_mfma_f32_32x32x16_bf16 v[80:95], v[132:135], v[248:251], 0
    v_mfma_f32_32x32x16_bf16 v[80:95], v[148:151], v[252:255], v[80:95]
    v_mfma_f32_32x32x16_bf16 v[96:111], v[136:139], v[248:251], 0
    v_mfma_f32_32x32x16_bf16 v[96:111], v[152:155], v[252:255], v[96:111]
    v_mfma_f32_32x32x16_bf16 v[112:127], v[140:143], v[248:251], 0
    v_mfma_f32_32x32x16_bf16 v[112:127], v[156:159], v[252:255], v[112:127]
    s_waitcnt vmcnt(8)
    s_barrier
    ds_read_b64_tr_b16 v[128:129], v56 offset:32768
    ds_read_b64_tr_b16 v[130:131], v56 offset:33792
    ds_read_b64_tr_b16 v[132:133], v57 offset:32768
    ds_read_b64_tr_b16 v[134:135], v57 offset:33792
    ds_read_b64_tr_b16 v[136:137], v58 offset:32768
    ds_read_b64_tr_b16 v[138:139], v58 offset:33792
    ds_read_b64_tr_b16 v[140:141], v59 offset:32768
    ds_read_b64_tr_b16 v[142:143], v59 offset:33792
    s_mov_b32 s8, 0
L_hspin:
    v_cmp_eq_u32 vcc, 0, v6
    s_add_u32 s8, s8, 1
    s_cmp_eq_u32 vcc_hi, 0
    s_cbranch_scc1 L_hok
    s_cmp_gt_u32 s8, 0x100000
    s_cbranch_scc1 L_hok
    buffer_load_dword v6, v4, s[64:67], 0 offen sc1
    s_waitcnt vmcnt(0)
    s_branch L_hspin
L_hok:
    v_cmp_ne_u32 vcc, s15, v6
    s_and_b32 s9, vcc_lo, 0xff
    s_cbranch_scc1 L_oslow
    v_cvt_pk_bf16_f32 v168, v64, v65
    v_cvt_pk_bf16_f32 v169, v66, v67
    v_cvt_pk_bf16_f32 v170, v68, v69
    v_cvt_pk_bf16_f32 v171, v70, v71
    v_cvt_pk_bf16_f32 v172, v72, v73
    v_cvt_pk_bf16_f32 v173, v74, v75
    v_cvt_pk_bf16_f32 v174, v76, v77
    v_cvt_pk_bf16_f32 v175, v78, v79
    s_nop 1
    v_permlane16_swap_b32 v168, v172
    v_permlane16_swap_b32 v169, v173
    v_permlane16_swap_b32 v170, v174
    v_permlane16_swap_b32 v171, v175
    buffer_store_dwordx4 v[168:171], v1, s[64:67], s10 offen offset:0
    buffer_store_dwordx4 v[172:175], v1, s[64:67], s10 offen offset:1024
    v_cvt_pk_bf16_f32 v176, v80, v81
    v_cvt_pk_bf16_f32 v177, v82, v83
    v_cvt_pk_bf16_f32 v178, v84, v85
    v_cvt_pk_bf16_f32 v179, v86, v87
    v_cvt_pk_bf16_f32 v180, v88, v89
    v_cvt_pk_bf16_f32 v181, v90, v91
    v_cvt_pk_bf16_f32 v182, v92, v93
    v_cvt_pk_bf16_f32 v183, v94, v95
    s_nop 1
    v_permlane16_swap_b32 v176, v180
    v_permlane16_swap_b32 v177, v181
    v_permlane16_swap_b32 v178, v182
    v_permlane16_swap_b32 v179, v183
    buffer_store_dwordx4 v[176:179], v1, s[64:67], s10 offen offset:2048
    buffer_store_dwordx4 v[180:183], v1, s[64:67], s10 offen offset:3072
    v_cvt_pk_bf16_f32 v184, v96, v97
    v_cvt_pk_bf16_f32 v185, v98, v99
    v_cvt_pk_bf16_f32 v186, v100, v101
    v_cvt_pk_bf16_f32 v187, v102, v103
    v_cvt_pk_bf16_f32 v188, v104, v105
    v_cvt_pk_bf16_f32 v189, v106, v107
    v_cvt_pk_bf16_f32 v190, v108, v109
    v_cvt_pk_bf16_f32 v191, v110, v111
    s_nop 1
    v_permlane16_swap_b32 v184, v188
    v_permlane16_swap_b32 v185, v189
    v_permlane16_swap_b32 v186, v190
    v_permlane16_swap_b32 v187, v191
    buffer_store_dwordx4 v[184:187], v1, s[64:67], s11 offen offset:0
    buffer_store_dwordx4 v[188:191], v1, s[64:67], s11 offen offset:1024
    v_cvt_pk_bf16_f32 v192, v112, v113
    v_cvt_pk_bf16_f32 v193, v114, v115
    v_cvt_pk_bf16_f32 v194, v116, v117
    v_cvt_pk_bf16_f32 v195, v118, v119
    v_cvt_pk_bf16_f32 v196, v120, v121
    v_cvt_pk_bf16_f32 v197, v122, v123
    v_cvt_pk_bf16_f32 v198, v124, v125
    v_cvt_pk_bf16_f32 v199, v126, v127
    s_nop 1
    v_permlane16_swap_b32 v192, v196
    v_permlane16_swap_b32 v193, v197
    v_permlane16_swap_b32 v194, v198
    v_permlane16_swap_b32 v195, v199
    buffer_store_dwordx4 v[192:195], v1, s[64:67], s11 offen offset:2048
    buffer_store_dwordx4 v[196:199], v1, s[64:67], s11 offen offset:3072
    s_branch L_odone
L_oslow:
    v_cvt_pk_bf16_f32 v168, v64, v65
    v_cvt_pk_bf16_f32 v169, v66, v67
    v_cvt_pk_bf16_f32 v170, v68, v69
    v_cvt_pk_bf16_f32 v171, v70, v71
    v_cvt_pk_bf16_f32 v172, v72, v73
    v_cvt_pk_bf16_f32 v173, v74, v75
    v_cvt_pk_bf16_f32 v174, v76, v77
    v_cvt_pk_bf16_f32 v175, v78, v79
    s_nop 1
    v_permlane16_swap_b32 v168, v172
    v_permlane16_swap_b32 v169, v173
    v_permlane16_swap_b32 v170, v174
    v_permlane16_swap_b32 v171, v175
    buffer_store_dwordx4 v[168:171], v1, s[64:67], s10 offen offset:0 sc1
    buffer_store_dwordx4 v[172:175], v1, s[64:67], s10 offen offset:1024 sc1
    v_cvt_pk_bf16_f32 v176, v80, v81
    v_cvt_pk_bf16_f32 v177, v82, v83
    v_cvt_pk_bf16_f32 v178, v84, v85
    v_cvt_pk_bf16_f32 v179, v86, v87
    v_cvt_pk_bf16_f32 v180, v88, v89
    v_cvt_pk_bf16_f32 v181, v90, v91
    v_cvt_pk_bf16_f32 v182, v92, v93
    v_cvt_pk_bf16_f32 v183, v94, v95
    s_nop 1
    v_permlane16_swap_b32 v176, v180
    v_permlane16_swap_b32 v177, v181
    v_permlane16_swap_b32 v178, v182
    v_permlane16_swap_b32 v179, v183
    buffer_store_dwordx4 v[176:179], v1, s[64:67], s10 offen offset:2048 sc1
    buffer_store_dwordx4 v[180:183], v1, s[64:67], s10 offen offset:3072 sc1
    v_cvt_pk_bf16_f32 v184, v96, v97
    v_cvt_pk_bf16_f32 v185, v98, v99
    v_cvt_pk_bf16_f32 v186, v100, v101
    v_cvt_pk_bf16_f32 v187, v102, v103
    v_cvt_pk_bf16_f32 v188, v104, v105
    v_cvt_pk_bf16_f32 v189, v106, v107
    v_cvt_pk_bf16_f32 v190, v108, v109
    v_cvt_pk_bf16_f32 v191, v110, v111
    s_nop 1
    v_permlane16_swap_b32 v184, v188
    v_permlane16_swap_b32 v185, v189
    v_permlane16_swap_b32 v186, v190
    v_permlane16_swap_b32 v187, v191
    buffer_store_dwordx4 v[184:187], v1, s[64:67], s11 offen offset:0 sc1
    buffer_store_dwordx4 v[188:191], v1, s[64:67], s11 offen offset:1024 sc1
    v_cvt_pk_bf16_f32 v192, v112, v113
    v_cvt_pk_bf16_f32 v193, v114, v115
    v_cvt_pk_bf16_f32 v194, v116, v117
    v_cvt_pk_bf16_f32 v195, v118, v119
    v_cvt_pk_bf16_f32 v196, v120, v121
    v_cvt_pk_bf16_f32 v197, v122, v123
    v_cvt_pk_bf16_f32 v198, v124, v125
    v_cvt_pk_bf16_f32 v199, v126, v127
    s_nop 1
    v_permlane16_swap_b32 v192, v196
    v_permlane16_swap_b32 v193, v197
    v_permlane16_swap_b32 v194, v198
    v_permlane16_swap_b32 v195, v199
    buffer_store_dwordx4 v[192:195], v1, s[64:67], s11 offen offset:2048 sc1
    buffer_store_dwordx4 v[196:199], v1, s[64:67], s11 offen offset:3072 sc1
L_odone:
    v_lshlrev_b32_e64 v7, s35, 1
    v_and_b32 v5, 7, v0
    v_lshlrev_b32 v5, 2, v5
    buffer_load_dword v6, v5, s[64:67], s14 offen sc1
    s_waitcnt lgkmcnt(6)
    v_mfma_f32_16x16x32_bf16 v[64:67], v[128:131], v[168:171], 0
    ds_read_b64_tr_b16 v[144:145], v32 offset:32768
    ds_read_b64_tr_b16 v[146:147], v32 offset:33792
    v_mfma_f32_16x16x32_bf16 v[68:71], v[128:131], v[172:175], 0
    ds_read_b64_tr_b16 v[148:149], v33 offset:32768
    s_waitcnt lgkmcnt(7)
    v_mfma_f32_16x16x32_bf16 v[80:83], v[132:135], v[168:171], 0
    ds_read_b64_tr_b16 v[150:151], v33 offset:33792
    ds_read_b64_tr_b16 v[152:153], v34 offset:32768
    v_mfma_f32_16x16x32_bf16 v[84:87], v[132:135], v[172:175], 0
    s_bfe_u32 s39, s29, 0x30008
    s_add_u32 m0, s68, 0
    s_lshl_b32 s40, s39, 18
    buffer_load_dwordx4 v18, s[60:63], s40 offen offset:0  lds
    s_waitcnt lgkmcnt(7)
    v_mfma_f32_16x16x32_bf16 v[96:99], v[136:139], v[168:171], 0
    ds_read_b64_tr_b16 v[154:155], v34 offset:33792
    ds_read_b64_tr_b16 v[156:157], v35 offset:32768
    v_mfma_f32_16x16x32_bf16 v[100:103], v[136:139], v[172:175], 0
    ds_read_b64_tr_b16 v[158:159], v35 offset:33792
    s_waitcnt lgkmcnt(8)
    v_mfma_f32_16x16x32_bf16 v[112:115], v[140:143], v[168:171], 0
    v_mfma_f32_16x16x32_bf16 v[116:119], v[140:143], v[172:175], 0
    buffer_load_dwordx4 v19, s[60:63], s40 offen offset:1024  lds
    s_waitcnt lgkmcnt(6)
    v_mfma_f32_16x16x32_bf16 v[72:75], v[144:147], v[168:171], 0
    ds_read_b64_tr_b16 v[128:129], v56 offset:40960
    ds_read_b64_tr_b16 v[130:131], v56 offset:41984
    v_mfma_f32_16x16x32_bf16 v[76:79], v[144:147], v[172:175], 0
    ds_read_b64_tr_b16 v[132:133], v57 offset:40960
    s_waitcnt lgkmcnt(7)
    v_mfma_f32_16x16x32_bf16 v[88:91], v[148:151], v[168:171], 0
    ds_read_b64_tr_b16 v[134:135], v57 offset:41984
    ds_read_b64_tr_b16 v[136:137], v58 offset:40960
    v_mfma_f32_16x16x32_bf16 v[92:95], v[148:151], v[172:175], 0
    buffer_load_dwordx4 v20, s[60:63], s40 offen offset:2048  lds
    s_waitcnt lgkmcnt(7)
    v_mfma_f32_16x16x32_bf16 v[104:107], v[152:155], v[168:171], 0
    ds_read_b64_tr_b16 v[138:139], v58 offset:41984
    ds_read_b64_tr_b16 v[140:141], v59 offset:40960
    v_mfma_f32_16x16x32_bf16 v[108:111], v[152:155], v[172:175], 0
    ds_read_b64_tr_b16 v[142:143], v59 offset:41984
    s_waitcnt lgkmcnt(8)
    v_mfma_f32_16x16x32_bf16 v[120:123], v[156:159], v[168:171], 0
    v_mfma_f32_16x16x32_bf16 v[124:127], v[156:159], v[172:175], 0
    buffer_load_dwordx4 v21, s[60:63], s40 offen offset:3072  lds
    s_waitcnt lgkmcnt(6)
    v_mfma_f32_16x16x32_bf16 v[64:67], v[128:131], v[176:179], v[64:67]
    ds_read_b64_tr_b16 v[144:145], v32 offset:40960
    ds_read_b64_tr_b16 v[146:147], v32 offset:41984
    v_mfma_f32_16x16x32_bf16 v[68:71], v[128:131], v[180:183], v[68:71]
    ds_read_b64_tr_b16 v[148:149], v33 offset:40960
    s_waitcnt lgkmcnt(7)
    v_mfma_f32_16x16x32_bf16 v[80:83], v[132:135], v[176:179], v[80:83]
    ds_read_b64_tr_b16 v[150:151], v33 offset:41984
    ds_read_b64_tr_b16 v[152:153], v34 offset:40960
    v_mfma_f32_16x16x32_bf16 v[84:87], v[132:135], v[180:183], v[84:87]
    s_add_u32 m0, s68, 4096
    s_add_u32 s40, s40, 32768
    buffer_load_dwordx4 v14, s[60:63], s40 offen offset:0  lds
    s_waitcnt lgkmcnt(7)
    v_mfma_f32_16x16x32_bf16 v[96:99], v[136:139], v[176:179], v[96:99]
    ds_read_b64_tr_b16 v[154:155], v34 offset:41984
    ds_read_b64_tr_b16 v[156:157], v35 offset:40960
    v_mfma_f32_16x16x32_bf16 v[100:103], v[136:139], v[180:183], v[100:103]
    ds_read_b64_tr_b16 v[158:159], v35 offset:41984
    s_waitcnt lgkmcnt(8)
    v_mfma_f32_16x16x32_bf16 v[112:115], v[140:143], v[176:179], v[112:115]
    v_mfma_f32_16x16x32_bf16 v[116:119], v[140:143], v[180:183], v[116:119]
    buffer_load_dwordx4 v15, s[60:63], s40 offen offset:1024  lds
    s_waitcnt vmcnt(7)
    s_cmp_lg_u32 s9, 0
    s_cbranch_scc1 L_fslow
    buffer_store_dword v7, v8, s[64:67], s14 offen
    s_branch L_fdone
L_fslow:
    buffer_store_dword v7, v8, s[64:67], s14 offen sc1
L_fdone:
    s_waitcnt lgkmcnt(6)
    v_mfma_f32_16x16x32_bf16 v[72:75], v[144:147], v[176:179], v[72:75]
    ds_read_b64_tr_b16 v[128:129], v56 offset:49152
    ds_read_b64_tr_b16 v[130:131], v56 offset:50176
    v_mfma_f32_16x16x32_bf16 v[76:79], v[144:147], v[180:183], v[76:79]
    ds_read_b64_tr_b16 v[132:133], v57 offset:49152
    s_waitcnt lgkmcnt(7)
    v_mfma_f32_16x16x32_bf16 v[88:91], v[148:151], v[176:179], v[88:91]
    ds_read_b64_tr_b16 v[134:135], v57 offset:50176
    ds_read_b64_tr_b16 v[136:137], v58 offset:49152
    v_mfma_f32_16x16x32_bf16 v[92:95], v[148:151], v[180:183], v[92:95]
    buffer_load_dwordx4 v16, s[60:63], s40 offen offset:2048  lds
    s_waitcnt lgkmcnt(7)
    v_mfma_f32_16x16x32_bf16 v[104:107], v[152:155], v[176:179], v[104:107]
    ds_read_b64_tr_b16 v[138:139], v58 offset:50176
    ds_read_b64_tr_b16 v[140:141], v59 offset:49152
    v_mfma_f32_16x16x32_bf16 v[108:111], v[152:155], v[180:183], v[108:111]
    ds_read_b64_tr_b16 v[142:143], v59 offset:50176
    s_waitcnt lgkmcnt(8)
    v_mfma_f32_16x16x32_bf16 v[120:123], v[156:159], v[176:179], v[120:123]
    v_mfma_f32_16x16x32_bf16 v[124:127], v[156:159], v[180:183], v[124:127]
    buffer_load_dwordx4 v17, s[60:63], s40 offen offset:3072  lds
    s_waitcnt lgkmcnt(6)
    v_mfma_f32_16x16x32_bf16 v[64:67], v[128:131], v[184:187], v[64:67]
    ds_read_b64_tr_b16 v[144:145], v32 offset:49152
    ds_read_b64_tr_b16 v[146:147], v32 offset:50176
    v_mfma_f32_16x16x32_bf16 v[68:71], v[128:131], v[188:191], v[68:71]
    ds_read_b64_tr_b16 v[148:149], v33 offset:49152
    s_waitcnt lgkmcnt(7)
    v_mfma_f32_16x16x32_bf16 v[80:83], v[132:135], v[184:187], v[80:83]
    ds_read_b64_tr_b16 v[150:151], v33 offset:50176
    ds_read_b64_tr_b16 v[152:153], v34 offset:49152
    v_mfma_f32_16x16x32_bf16 v[84:87], v[132:135], v[188:191], v[84:87]
    s_waitcnt lgkmcnt(7)
    v_mfma_f32_16x16x32_bf16 v[96:99], v[136:139], v[184:187], v[96:99]
    ds_read_b64_tr_b16 v[154:155], v34 offset:50176
    ds_read_b64_tr_b16 v[156:157], v35 offset:49152
    v_mfma_f32_16x16x32_bf16 v[100:103], v[136:139], v[188:191], v[100:103]
    ds_read_b64_tr_b16 v[158:159], v35 offset:50176
    s_waitcnt lgkmcnt(8)
    v_mfma_f32_16x16x32_bf16 v[112:115], v[140:143], v[184:187], v[112:115]
    v_mfma_f32_16x16x32_bf16 v[116:119], v[140:143], v[188:191], v[116:119]
    s_waitcnt lgkmcnt(6)
    v_mfma_f32_16x16x32_bf16 v[72:75], v[144:147], v[184:187], v[72:75]
    ds_read_b64_tr_b16 v[128:129], v56 offset:57344
    ds_read_b64_tr_b16 v[130:131], v56 offset:58368
    v_mfma_f32_16x16x32_bf16 v[76:79], v[144:147], v[188:191], v[76:79]
    ds_read_b64_tr_b16 v[132:133], v57 offset:57344
    s_waitcnt lgkmcnt(7)
    v_mfma_f32_16x16x32_bf16 v[88:91], v[148:151], v[184:187], v[88:91]
    ds_read_b64_tr_b16 v[134:135], v57 offset:58368
    ds_read_b64_tr_b16 v[136:137], v58 offset:57344
    v_mfma_f32_16x16x32_bf16 v[92:95], v[148:151], v[188:191], v[92:95]
    s_waitcnt lgkmcnt(7)
    v_mfma_f32_16x16x32_bf16 v[104:107], v[152:155], v[184:187], v[104:107]
    ds_read_b64_tr_b16 v[138:139], v58 offset:58368
    ds_read_b64_tr_b16 v[140:141], v59 offset:57344
    v_mfma_f32_16x16x32_bf16 v[108:111], v[152:155], v[188:191], v[108:111]
    ds_read_b64_tr_b16 v[142:143], v59 offset:58368
    s_waitcnt lgkmcnt(8)
    v_mfma_f32_16x16x32_bf16 v[120:123], v[156:159], v[184:187], v[120:123]
    v_mfma_f32_16x16x32_bf16 v[124:127], v[156:159], v[188:191], v[124:127]
    s_waitcnt lgkmcnt(6)
    v_mfma_f32_16x16x32_bf16 v[64:67], v[128:131], v[192:195], v[64:67]
    ds_read_b64_tr_b16 v[144:145], v32 offset:57344
    ds_read_b64_tr_b16 v[146:147], v32 offset:58368
    v_mfma_f32_16x16x32_bf16 v[68:71], v[128:131], v[196:199], v[68:71]
    ds_read_b64_tr_b16 v[148:149], v33 offset:57344
    s_waitcnt lgkmcnt(7)
    v_mfma_f32_16x16x32_bf16 v[80:83], v[132:135], v[192:195], v[80:83]
    ds_read_b64_tr_b16 v[150:151], v33 offset:58368
    ds_read_b64_tr_b16 v[152:153], v34 offset:57344
    v_mfma_f32_16x16x32_bf16 v[84:87], v[132:135], v[196:199], v[84:87]
    s_waitcnt lgkmcnt(7)
    v_mfma_f32_16x16x32_bf16 v[96:99], v[136:139], v[192:195], v[96:99]
    ds_read_b64_tr_b16 v[154:155], v34 offset:58368
    ds_read_b64_tr_b16 v[156:157], v35 offset:57344
    v_mfma_f32_16x16x32_bf16 v[100:103], v[136:139], v[196:199], v[100:103]
    ds_read_b64_tr_b16 v[158:159], v35 offset:58368
    s_waitcnt lgkmcnt(8)
    v_mfma_f32_16x16x32_bf16 v[112:115], v[140:143], v[192:195], v[112:115]
    v_mfma_f32_16x16x32_bf16 v[116:119], v[140:143], v[196:199], v[116:119]
    s_mov_b32 s8, 0
    s_waitcnt vmcnt(9)
    v_cmp_eq_u32 vcc, 0, v6
    s_lshl_b32 s39, 1, s35
    s_xor_b32 s39, s39, 0xff
    s_and_b32 s39, s39, vcc_lo
    s_cbranch_scc0 L_f1ok
L_f1:
    buffer_load_dword v6, v5, s[64:67], s14 offen sc1
    s_add_u32 s8, s8, 1
    s_cmp_gt_u32 s8, 0x100000
    s_cbranch_scc1 L_f1ok
    s_waitcnt vmcnt(0)
    v_cmp_eq_u32 vcc, 0, v6
    s_cbranch_vccnz L_f1
L_f1ok:
    s_bfe_u32 s30, s29, 0x30004
    s_lshl_b32 s30, s30, 13
    s_add_u32 s41, s69, s30
    buffer_load_dwordx4 a[32:35], v1, s[64:67], s41 offen offset:0 sc1
    buffer_load_dwordx4 a[36:39], v1, s[64:67], s41 offen offset:1024 sc1
    buffer_load_dwordx4 a[40:43], v1, s[64:67], s41 offen offset:2048 sc1
    buffer_load_dwordx4 a[44:47], v1, s[64:67], s41 offen offset:3072 sc1
    s_add_u32 s41, s41, 4096
    buffer_load_dwordx4 a[48:51], v1, s[64:67], s41 offen offset:0 sc1
    buffer_load_dwordx4 a[52:55], v1, s[64:67], s41 offen offset:1024 sc1
    buffer_load_dwordx4 a[56:59], v1, s[64:67], s41 offen offset:2048 sc1
    buffer_load_dwordx4 a[60:63], v1, s[64:67], s41 offen offset:3072 sc1
    s_waitcnt lgkmcnt(0)
    s_barrier
    v_mfma_f32_16x16x32_bf16 v[72:75], v[144:147], v[192:195], v[72:75]
    ds_read_b64_tr_b16 v[128:129], v60 offset:0
    ds_read_b64_tr_b16 v[130:131], v60 offset:1024
    v_mfma_f32_16x16x32_bf16 v[76:79], v[144:147], v[196:199], v[76:79]
    ds_read_b64_tr_b16 v[132:133], v61 offset:0
    v_mfma_f32_16x16x32_bf16 v[88:91], v[148:151], v[192:195], v[88:91]
    ds_read_b64_tr_b16 v[134:135], v61 offset:1024
    ds_read_b64_tr_b16 v[136:137], v62 offset:0
    v_mfma_f32_16x16x32_bf16 v[92:95], v[148:151], v[196:199], v[92:95]
    s_bfe_u32 s30, s29, 0x30008
    s_lshl_b32 s30, s30, 13
    s_add_u32 s41, s69, s30
    buffer_load_dwordx4 a[64:67], v1, s[64:67], s41 offen offset:0 sc1
    v_mfma_f32_16x16x32_bf16 v[104:107], v[152:155], v[192:195], v[104:107]
    ds_read_b64_tr_b16 v[138:139], v62 offset:1024
    ds_read_b64_tr_b16 v[140:141], v63 offset:0
    v_mfma_f32_16x16x32_bf16 v[108:111], v[152:155], v[196:199], v[108:111]
    ds_read_b64_tr_b16 v[142:143], v63 offset:1024
    v_mfma_f32_16x16x32_bf16 v[120:123], v[156:159], v[192:195], v[120:123]
    v_mfma_f32_16x16x32_bf16 v[124:127], v[156:159], v[196:199], v[124:127]
    buffer_load_dwordx4 a[68:71], v1, s[64:67], s41 offen offset:1024 sc1
    s_waitcnt vmcnt(8)
    s_waitcnt lgkmcnt(6)
    v_mfma_f32_16x16x32_bf16 v[64:67], v[128:131], a[32:35], v[64:67]
    ds_read_b64_tr_b16 v[144:145], v36 offset:0
    ds_read_b64_tr_b16 v[146:147], v36 offset:1024
    v_mfma_f32_16x16x32_bf16 v[68:71], v[128:131], a[36:39], v[68:71]
    ds_read_b64_tr_b16 v[148:149], v37 offset:0
    s_waitcnt lgkmcnt(7)
    v_mfma_f32_16x16x32_bf16 v[80:83], v[132:135], a[32:35], v[80:83]
    ds_read_b64_tr_b16 v[150:151], v37 offset:1024
    ds_read_b64_tr_b16 v[152:153], v38 offset:0
    v_mfma_f32_16x16x32_bf16 v[84:87], v[132:135], a[36:39], v[84:87]
    buffer_load_dwordx4 a[72:75], v1, s[64:67], s41 offen offset:2048 sc1
    s_waitcnt lgkmcnt(7)
    v_mfma_f32_16x16x32_bf16 v[96:99], v[136:139], a[32:35], v[96:99]
    ds_read_b64_tr_b16 v[154:155], v38 offset:1024
    ds_read_b64_tr_b16 v[156:157], v39 offset:0
    v_mfma_f32_16x16x32_bf16 v[100:103], v[136:139], a[36:39], v[100:103]
    ds_read_b64_tr_b16 v[158:159], v39 offset:1024
    s_waitcnt lgkmcnt(8)
    v_mfma_f32_16x16x32_bf16 v[112:115], v[140:143], a[32:35], v[112:115]
    v_mfma_f32_16x16x32_bf16 v[116:119], v[140:143], a[36:39], v[116:119]
    buffer_load_dwordx4 a[76:79], v1, s[64:67], s41 offen offset:3072 sc1
    s_waitcnt lgkmcnt(6)
    v_mfma_f32_16x16x32_bf16 v[72:75], v[144:147], a[32:35], v[72:75]
    ds_read_b64_tr_b16 v[128:129], v60 offset:8192
    ds_read_b64_tr_b16 v[130:131], v60 offset:9216
    v_mfma_f32_16x16x32_bf16 v[76:79], v[144:147], a[36:39], v[76:79]
    ds_read_b64_tr_b16 v[132:133], v61 offset:8192
    s_waitcnt lgkmcnt(7)
    v_mfma_f32_16x16x32_bf16 v[88:91], v[148:151], a[32:35], v[88:91]
    ds_read_b64_tr_b16 v[134:135], v61 offset:9216
    ds_read_b64_tr_b16 v[136:137], v62 offset:8192
    v_mfma_f32_16x16x32_bf16 v[92:95], v[148:151], a[36:39], v[92:95]
    s_add_u32 s41, s41, 4096
    buffer_load_dwordx4 a[80:83], v1, s[64:67], s41 offen offset:0 sc1
    s_waitcnt lgkmcnt(7)
    v_mfma_f32_16x16x32_bf16 v[104:107], v[152:155], a[32:35], v[104:107]
    ds_read_b64_tr_b16 v[138:139], v62 offset:9216
    ds_read_b64_tr_b16 v[140:141], v63 offset:8192
    v_mfma_f32_16x16x32_bf16 v[108:111], v[152:155], a[36:39], v[108:111]
    ds_read_b64_tr_b16 v[142:143], v63 offset:9216
    s_waitcnt lgkmcnt(8)
    v_mfma_f32_16x16x32_bf16 v[120:123], v[156:159], a[32:35], v[120:123]
    v_mfma_f32_16x16x32_bf16 v[124:127], v[156:159], a[36:39], v[124:127]
    s_bfe_u32 s39, s29, 0x3000c
    s_add_u32 m0, s68, 32768
    s_lshl_b32 s40, s39, 18
    buffer_load_dwordx4 v18, s[60:63], s40 offen offset:0  lds
    s_waitcnt vmcnt(10)
    s_waitcnt lgkmcnt(6)
    v_mfma_f32_16x16x32_bf16 v[64:67], v[128:131], a[40:43], v[64:67]
    ds_read_b64_tr_b16 v[144:145], v36 offset:8192
    ds_read_b64_tr_b16 v[146:147], v36 offset:9216
    v_mfma_f32_16x16x32_bf16 v[68:71], v[128:131], a[44:47], v[68:71]
    ds_read_b64_tr_b16 v[148:149], v37 offset:8192
    s_waitcnt lgkmcnt(7)
    v_mfma_f32_16x16x32_bf16 v[80:83], v[132:135], a[40:43], v[80:83]
    ds_read_b64_tr_b16 v[150:151], v37 offset:9216
    ds_read_b64_tr_b16 v[152:153], v38 offset:8192
    v_mfma_f32_16x16x32_bf16 v[84:87], v[132:135], a[44:47], v[84:87]
    buffer_load_dwordx4 v19, s[60:63], s40 offen offset:1024  lds
    s_waitcnt lgkmcnt(7)
    v_mfma_f32_16x16x32_bf16 v[96:99], v[136:139], a[40:43], v[96:99]
    ds_read_b64_tr_b16 v[154:155], v38 offset:9216
    ds_read_b64_tr_b16 v[156:157], v39 offset:8192
    v_mfma_f32_16x16x32_bf16 v[100:103], v[136:139], a[44:47], v[100:103]
    ds_read_b64_tr_b16 v[158:159], v39 offset:9216
    s_waitcnt lgkmcnt(8)
    v_mfma_f32_16x16x32_bf16 v[112:115], v[140:143], a[40:43], v[112:115]
    v_mfma_f32_16x16x32_bf16 v[116:119], v[140:143], a[44:47], v[116:119]
    buffer_load_dwordx4 v20, s[60:63], s40 offen offset:2048  lds
    s_waitcnt lgkmcnt(6)
    v_mfma_f32_16x16x32_bf16 v[72:75], v[144:147], a[40:43], v[72:75]
    ds_read_b64_tr_b16 v[128:129], v60 offset:16384
    ds_read_b64_tr_b16 v[130:131], v60 offset:17408
    v_mfma_f32_16x16x32_bf16 v[76:79], v[144:147], a[44:47], v[76:79]
    ds_read_b64_tr_b16 v[132:133], v61 offset:16384
    s_waitcnt lgkmcnt(7)
    v_mfma_f32_16x16x32_bf16 v[88:91], v[148:151], a[40:43], v[88:91]
    ds_read_b64_tr_b16 v[134:135], v61 offset:17408
    ds_read_b64_tr_b16 v[136:137], v62 offset:16384
    v_mfma_f32_16x16x32_bf16 v[92:95], v[148:151], a[44:47], v[92:95]
    buffer_load_dwordx4 v21, s[60:63], s40 offen offset:3072  lds
    s_waitcnt lgkmcnt(7)
    v_mfma_f32_16x16x32_bf16 v[104:107], v[152:155], a[40:43], v[104:107]
    ds_read_b64_tr_b16 v[138:139], v62 offset:17408
    ds_read_b64_tr_b16 v[140:141], v63 offset:16384
    v_mfma_f32_16x16x32_bf16 v[108:111], v[152:155], a[44:47], v[108:111]
    ds_read_b64_tr_b16 v[142:143], v63 offset:17408
    s_waitcnt lgkmcnt(8)
    v_mfma_f32_16x16x32_bf16 v[120:123], v[156:159], a[40:43], v[120:123]
    v_mfma_f32_16x16x32_bf16 v[124:127], v[156:159], a[44:47], v[124:127]
    s_add_u32 m0, s68, 36864
    s_add_u32 s40, s40, 32768
    buffer_load_dwordx4 v14, s[60:63], s40 offen offset:0  lds
    s_waitcnt vmcnt(12)
    s_waitcnt lgkmcnt(6)
    v_mfma_f32_16x16x32_bf16 v[64:67], v[128:131], a[48:51], v[64:67]
    ds_read_b64_tr_b16 v[144:145], v36 offset:16384
    ds_read_b64_tr_b16 v[146:147], v36 offset:17408
    v_mfma_f32_16x16x32_bf16 v[68:71], v[128:131], a[52:55], v[68:71]
    ds_read_b64_tr_b16 v[148:149], v37 offset:16384
    s_waitcnt lgkmcnt(7)
    v_mfma_f32_16x16x32_bf16 v[80:83], v[132:135], a[48:51], v[80:83]
    ds_read_b64_tr_b16 v[150:151], v37 offset:17408
    ds_read_b64_tr_b16 v[152:153], v38 offset:16384
    v_mfma_f32_16x16x32_bf16 v[84:87], v[132:135], a[52:55], v[84:87]
    buffer_load_dwordx4 v15, s[60:63], s40 offen offset:1024  lds
    s_waitcnt lgkmcnt(7)
    v_mfma_f32_16x16x32_bf16 v[96:99], v[136:139], a[48:51], v[96:99]
    ds_read_b64_tr_b16 v[154:155], v38 offset:17408
    ds_read_b64_tr_b16 v[156:157], v39 offset:16384
    v_mfma_f32_16x16x32_bf16 v[100:103], v[136:139], a[52:55], v[100:103]
    ds_read_b64_tr_b16 v[158:159], v39 offset:17408
    s_waitcnt lgkmcnt(8)
    v_mfma_f32_16x16x32_bf16 v[112:115], v[140:143], a[48:51], v[112:115]
    v_mfma_f32_16x16x32_bf16 v[116:119], v[140:143], a[52:55], v[116:119]
    buffer_load_dwordx4 v16, s[60:63], s40 offen offset:2048  lds
    s_waitcnt lgkmcnt(6)
    v_mfma_f32_16x16x32_bf16 v[72:75], v[144:147], a[48:51], v[72:75]
    ds_read_b64_tr_b16 v[128:129], v60 offset:24576
    ds_read_b64_tr_b16 v[130:131], v60 offset:25600
    v_mfma_f32_16x16x32_bf16 v[76:79], v[144:147], a[52:55], v[76:79]
    ds_read_b64_tr_b16 v[132:133], v61 offset:24576
    s_waitcnt lgkmcnt(7)
    v_mfma_f32_16x16x32_bf16 v[88:91], v[148:151], a[48:51], v[88:91]
    ds_read_b64_tr_b16 v[134:135], v61 offset:25600
    ds_read_b64_tr_b16 v[136:137], v62 offset:24576
    v_mfma_f32_16x16x32_bf16 v[92:95], v[148:151], a[52:55], v[92:95]
    buffer_load_dwordx4 v17, s[60:63], s40 offen offset:3072  lds
    s_waitcnt lgkmcnt(7)
    v_mfma_f32_16x16x32_bf16 v[104:107], v[152:155], a[48:51], v[104:107]
    ds_read_b64_tr_b16 v[138:139], v62 offset:25600
    ds_read_b64_tr_b16 v[140:141], v63 offset:24576
    v_mfma_f32_16x16x32_bf16 v[108:111], v[152:155], a[52:55], v[108:111]
    ds_read_b64_tr_b16 v[142:143], v63 offset:25600
    s_waitcnt lgkmcnt(8)
    v_mfma_f32_16x16x32_bf16 v[120:123], v[156:159], a[48:51], v[120:123]
    v_mfma_f32_16x16x32_bf16 v[124:127], v[156:159], a[52:55], v[124:127]
    buffer_load_dwordx4 a[84:87], v1, s[64:67], s41 offen offset:1024 sc1
    s_waitcnt vmcnt(14)
    s_waitcnt lgkmcnt(6)
    v_mfma_f32_16x16x32_bf16 v[64:67], v[128:131], a[56:59], v[64:67]
    ds_read_b64_tr_b16 v[144:145], v36 offset:24576
    ds_read_b64_tr_b16 v[146:147], v36 offset:25600
    v_mfma_f32_16x16x32_bf16 v[68:71], v[128:131], a[60:63], v[68:71]
    ds_read_b64_tr_b16 v[148:149], v37 offset:24576
    s_waitcnt lgkmcnt(7)
    v_mfma_f32_16x16x32_bf16 v[80:83], v[132:135], a[56:59], v[80:83]
    ds_read_b64_tr_b16 v[150:151], v37 offset:25600
    ds_read_b64_tr_b16 v[152:153], v38 offset:24576
    v_mfma_f32_16x16x32_bf16 v[84:87], v[132:135], a[60:63], v[84:87]
    buffer_load_dwordx4 a[88:91], v1, s[64:67], s41 offen offset:2048 sc1
    s_waitcnt lgkmcnt(7)
    v_mfma_f32_16x16x32_bf16 v[96:99], v[136:139], a[56:59], v[96:99]
    ds_read_b64_tr_b16 v[154:155], v38 offset:25600
    ds_read_b64_tr_b16 v[156:157], v39 offset:24576
    v_mfma_f32_16x16x32_bf16 v[100:103], v[136:139], a[60:63], v[100:103]
    ds_read_b64_tr_b16 v[158:159], v39 offset:25600
    s_waitcnt lgkmcnt(8)
    v_mfma_f32_16x16x32_bf16 v[112:115], v[140:143], a[56:59], v[112:115]
    v_mfma_f32_16x16x32_bf16 v[116:119], v[140:143], a[60:63], v[116:119]
    buffer_load_dwordx4 a[92:95], v1, s[64:67], s41 offen offset:3072 sc1
    s_waitcnt lgkmcnt(0)
    s_barrier
    v_mfma_f32_16x16x32_bf16 v[72:75], v[144:147], a[56:59], v[72:75]
    ds_read_b64_tr_b16 v[128:129], v52 offset:0
    ds_read_b64_tr_b16 v[130:131], v52 offset:1024
    v_mfma_f32_16x16x32_bf16 v[76:79], v[144:147], a[60:63], v[76:79]
    ds_read_b64_tr_b16 v[132:133], v53 offset:0
    v_mfma_f32_16x16x32_bf16 v[88:91], v[148:151], a[56:59], v[88:91]
    ds_read_b64_tr_b16 v[134:135], v53 offset:1024
    ds_read_b64_tr_b16 v[136:137], v54 offset:0
    v_mfma_f32_16x16x32_bf16 v[92:95], v[148:151], a[60:63], v[92:95]
    s_bfe_u32 s30, s29, 0x3000c
    s_lshl_b32 s30, s30, 13
    s_add_u32 s41, s69, s30
    buffer_load_dwordx4 a[96:99], v1, s[64:67], s41 offen offset:0 sc1
    v_mfma_f32_16x16x32_bf16 v[104:107], v[152:155], a[56:59], v[104:107]
    ds_read_b64_tr_b16 v[138:139], v54 offset:1024
    ds_read_b64_tr_b16 v[140:141], v55 offset:0
    v_mfma_f32_16x16x32_bf16 v[108:111], v[152:155], a[60:63], v[108:111]
    ds_read_b64_tr_b16 v[142:143], v55 offset:1024
    v_mfma_f32_16x16x32_bf16 v[120:123], v[156:159], a[56:59], v[120:123]
    v_mfma_f32_16x16x32_bf16 v[124:127], v[156:159], a[60:63], v[124:127]
    buffer_load_dwordx4 a[100:103], v1, s[64:67], s41 offen offset:1024 sc1
    s_waitcnt vmcnt(16)
    s_waitcnt lgkmcnt(6)
    v_mfma_f32_16x16x32_bf16 v[64:67], v[128:131], a[64:67], v[64:67]
    ds_read_b64_tr_b16 v[144:145], v28 offset:0
    ds_read_b64_tr_b16 v[146:147], v28 offset:1024
    v_mfma_f32_16x16x32_bf16 v[68:71], v[128:131], a[68:71], v[68:71]
    ds_read_b64_tr_b16 v[148:149], v29 offset:0
    s_waitcnt lgkmcnt(7)
    v_mfma_f32_16x16x32_bf16 v[80:83], v[132:135], a[64:67], v[80:83]
    ds_read_b64_tr_b16 v[150:151], v29 offset:1024
    ds_read_b64_tr_b16 v[152:153], v30 offset:0
    v_mfma_f32_16x16x32_bf16 v[84:87], v[132:135], a[68:71], v[84:87]
    buffer_load_dwordx4 a[104:107], v1, s[64:67], s41 offen offset:2048 sc1
    s_waitcnt lgkmcnt(7)
    v_mfma_f32_16x16x32_bf16 v[96:99], v[136:139], a[64:67], v[96:99]
    ds_read_b64_tr_b16 v[154:155], v30 offset:1024
    ds_read_b64_tr_b16 v[156:157], v31 offset:0
    v_mfma_f32_16x16x32_bf16 v[100:103], v[136:139], a[68:71], v[100:103]
    ds_read_b64_tr_b16 v[158:159], v31 offset:1024
    s_waitcnt lgkmcnt(8)
    v_mfma_f32_16x16x32_bf16 v[112:115], v[140:143], a[64:67], v[112:115]
    v_mfma_f32_16x16x32_bf16 v[116:119], v[140:143], a[68:71], v[116:119]
    buffer_load_dwordx4 a[108:111], v1, s[64:67], s41 offen offset:3072 sc1
    s_waitcnt lgkmcnt(6)
    v_mfma_f32_16x16x32_bf16 v[72:75], v[144:147], a[64:67], v[72:75]
    ds_read_b64_tr_b16 v[128:129], v52 offset:8192
    ds_read_b64_tr_b16 v[130:131], v52 offset:9216
    v_mfma_f32_16x16x32_bf16 v[76:79], v[144:147], a[68:71], v[76:79]
    ds_read_b64_tr_b16 v[132:133], v53 offset:8192
    s_waitcnt lgkmcnt(7)
    v_mfma_f32_16x16x32_bf16 v[88:91], v[148:151], a[64:67], v[88:91]
    ds_read_b64_tr_b16 v[134:135], v53 offset:9216
    ds_read_b64_tr_b16 v[136:137], v54 offset:8192
    v_mfma_f32_16x16x32_bf16 v[92:95], v[148:151], a[68:71], v[92:95]
    s_add_u32 s41, s41, 4096
    buffer_load_dwordx4 a[112:115], v1, s[64:67], s41 offen offset:0 sc1
    s_waitcnt lgkmcnt(7)
    v_mfma_f32_16x16x32_bf16 v[104:107], v[152:155], a[64:67], v[104:107]
    ds_read_b64_tr_b16 v[138:139], v54 offset:9216
    ds_read_b64_tr_b16 v[140:141], v55 offset:8192
    v_mfma_f32_16x16x32_bf16 v[108:111], v[152:155], a[68:71], v[108:111]
    ds_read_b64_tr_b16 v[142:143], v55 offset:9216
    s_waitcnt lgkmcnt(8)
    v_mfma_f32_16x16x32_bf16 v[120:123], v[156:159], a[64:67], v[120:123]
    v_mfma_f32_16x16x32_bf16 v[124:127], v[156:159], a[68:71], v[124:127]
    s_bfe_u32 s39, s29, 0x30010
    s_add_u32 m0, s68, 65536
    s_lshl_b32 s40, s39, 18
    buffer_load_dwordx4 v18, s[60:63], s40 offen offset:0  lds
    s_waitcnt vmcnt(18)
    s_waitcnt lgkmcnt(6)
    v_mfma_f32_16x16x32_bf16 v[64:67], v[128:131], a[72:75], v[64:67]
    ds_read_b64_tr_b16 v[144:145], v28 offset:8192
    ds_read_b64_tr_b16 v[146:147], v28 offset:9216
    v_mfma_f32_16x16x32_bf16 v[68:71], v[128:131], a[76:79], v[68:71]
    ds_read_b64_tr_b16 v[148:149], v29 offset:8192
    s_waitcnt lgkmcnt(7)
    v_mfma_f32_16x16x32_bf16 v[80:83], v[132:135], a[72:75], v[80:83]
    ds_read_b64_tr_b16 v[150:151], v29 offset:9216
    ds_read_b64_tr_b16 v[152:153], v30 offset:8192
    v_mfma_f32_16x16x32_bf16 v[84:87], v[132:135], a[76:79], v[84:87]
    buffer_load_dwordx4 v19, s[60:63], s40 offen offset:1024  lds
    s_waitcnt lgkmcnt(7)
    v_mfma_f32_16x16x32_bf16 v[96:99], v[136:139], a[72:75], v[96:99]
    ds_read_b64_tr_b16 v[154:155], v30 offset:9216
    ds_read_b64_tr_b16 v[156:157], v31 offset:8192
    v_mfma_f32_16x16x32_bf16 v[100:103], v[136:139], a[76:79], v[100:103]
    ds_read_b64_tr_b16 v[158:159], v31 offset:9216
    s_waitcnt lgkmcnt(8)
    v_mfma_f32_16x16x32_bf16 v[112:115], v[140:143], a[72:75], v[112:115]
    v_mfma_f32_16x16x32_bf16 v[116:119], v[140:143], a[76:79], v[116:119]
    buffer_load_dwordx4 v20, s[60:63], s40 offen offset:2048  lds
    s_waitcnt lgkmcnt(6)
    v_mfma_f32_16x16x32_bf16 v[72:75], v[144:147], a[72:75], v[72:75]
    ds_read_b64_tr_b16 v[128:129], v52 offset:16384
    ds_read_b64_tr_b16 v[130:131], v52 offset:17408
    v_mfma_f32_16x16x32_bf16 v[76:79], v[144:147], a[76:79], v[76:79]
    ds_read_b64_tr_b16 v[132:133], v53 offset:16384
    s_waitcnt lgkmcnt(7)
    v_mfma_f32_16x16x32_bf16 v[88:91], v[148:151], a[72:75], v[88:91]
    ds_read_b64_tr_b16 v[134:135], v53 offset:17408
    ds_read_b64_tr_b16 v[136:137], v54 offset:16384
    v_mfma_f32_16x16x32_bf16 v[92:95], v[148:151], a[76:79], v[92:95]
    buffer_load_dwordx4 v21, s[60:63], s40 offen offset:3072  lds
    s_waitcnt lgkmcnt(7)
    v_mfma_f32_16x16x32_bf16 v[104:107], v[152:155], a[72:75], v[104:107]
    ds_read_b64_tr_b16 v[138:139], v54 offset:17408
    ds_read_b64_tr_b16 v[140:141], v55 offset:16384
    v_mfma_f32_16x16x32_bf16 v[108:111], v[152:155], a[76:79], v[108:111]
    ds_read_b64_tr_b16 v[142:143], v55 offset:17408
    s_waitcnt lgkmcnt(8)
    v_mfma_f32_16x16x32_bf16 v[120:123], v[156:159], a[72:75], v[120:123]
    v_mfma_f32_16x16x32_bf16 v[124:127], v[156:159], a[76:79], v[124:127]
    s_add_u32 m0, s68, 69632
    s_add_u32 s40, s40, 32768
    buffer_load_dwordx4 v14, s[60:63], s40 offen offset:0  lds
    s_waitcnt vmcnt(12)
    s_waitcnt lgkmcnt(6)
    v_mfma_f32_16x16x32_bf16 v[64:67], v[128:131], a[80:83], v[64:67]
    ds_read_b64_tr_b16 v[144:145], v28 offset:16384
    ds_read_b64_tr_b16 v[146:147], v28 offset:17408
    v_mfma_f32_16x16x32_bf16 v[68:71], v[128:131], a[84:87], v[68:71]
    ds_read_b64_tr_b16 v[148:149], v29 offset:16384
    s_waitcnt lgkmcnt(7)
    v_mfma_f32_16x16x32_bf16 v[80:83], v[132:135], a[80:83], v[80:83]
    ds_read_b64_tr_b16 v[150:151], v29 offset:17408
    ds_read_b64_tr_b16 v[152:153], v30 offset:16384
    v_mfma_f32_16x16x32_bf16 v[84:87], v[132:135], a[84:87], v[84:87]
    buffer_load_dwordx4 v15, s[60:63], s40 offen offset:1024  lds
    s_waitcnt lgkmcnt(7)
    v_mfma_f32_16x16x32_bf16 v[96:99], v[136:139], a[80:83], v[96:99]
    ds_read_b64_tr_b16 v[154:155], v30 offset:17408
    ds_read_b64_tr_b16 v[156:157], v31 offset:16384
    v_mfma_f32_16x16x32_bf16 v[100:103], v[136:139], a[84:87], v[100:103]
    ds_read_b64_tr_b16 v[158:159], v31 offset:17408
    s_waitcnt lgkmcnt(8)
    v_mfma_f32_16x16x32_bf16 v[112:115], v[140:143], a[80:83], v[112:115]
    v_mfma_f32_16x16x32_bf16 v[116:119], v[140:143], a[84:87], v[116:119]
    buffer_load_dwordx4 v16, s[60:63], s40 offen offset:2048  lds
    s_waitcnt lgkmcnt(6)
    v_mfma_f32_16x16x32_bf16 v[72:75], v[144:147], a[80:83], v[72:75]
    ds_read_b64_tr_b16 v[128:129], v52 offset:24576
    ds_read_b64_tr_b16 v[130:131], v52 offset:25600
    v_mfma_f32_16x16x32_bf16 v[76:79], v[144:147], a[84:87], v[76:79]
    ds_read_b64_tr_b16 v[132:133], v53 offset:24576
    s_waitcnt lgkmcnt(7)
    v_mfma_f32_16x16x32_bf16 v[88:91], v[148:151], a[80:83], v[88:91]
    ds_read_b64_tr_b16 v[134:135], v53 offset:25600
    ds_read_b64_tr_b16 v[136:137], v54 offset:24576
    v_mfma_f32_16x16x32_bf16 v[92:95], v[148:151], a[84:87], v[92:95]
    buffer_load_dwordx4 v17, s[60:63], s40 offen offset:3072  lds
    s_waitcnt lgkmcnt(7)
    v_mfma_f32_16x16x32_bf16 v[104:107], v[152:155], a[80:83], v[104:107]
    ds_read_b64_tr_b16 v[138:139], v54 offset:25600
    ds_read_b64_tr_b16 v[140:141], v55 offset:24576
    v_mfma_f32_16x16x32_bf16 v[108:111], v[152:155], a[84:87], v[108:111]
    ds_read_b64_tr_b16 v[142:143], v55 offset:25600
    s_waitcnt lgkmcnt(8)
    v_mfma_f32_16x16x32_bf16 v[120:123], v[156:159], a[80:83], v[120:123]
    v_mfma_f32_16x16x32_bf16 v[124:127], v[156:159], a[84:87], v[124:127]
    buffer_load_dwordx4 a[116:119], v1, s[64:67], s41 offen offset:1024 sc1
    s_waitcnt vmcnt(14)
    s_waitcnt lgkmcnt(6)
    v_mfma_f32_16x16x32_bf16 v[64:67], v[128:131], a[88:91], v[64:67]
    ds_read_b64_tr_b16 v[144:145], v28 offset:24576
    ds_read_b64_tr_b16 v[146:147], v28 offset:25600
    v_mfma_f32_16x16x32_bf16 v[68:71], v[128:131], a[92:95], v[68:71]
    ds_read_b64_tr_b16 v[148:149], v29 offset:24576
    s_waitcnt lgkmcnt(7)
    v_mfma_f32_16x16x32_bf16 v[80:83], v[132:135], a[88:91], v[80:83]
    ds_read_b64_tr_b16 v[150:151], v29 offset:25600
    ds_read_b64_tr_b16 v[152:153], v30 offset:24576
    v_mfma_f32_16x16x32_bf16 v[84:87], v[132:135], a[92:95], v[84:87]
    buffer_load_dwordx4 a[120:123], v1, s[64:67], s41 offen offset:2048 sc1
    s_waitcnt lgkmcnt(7)
    v_mfma_f32_16x16x32_bf16 v[96:99], v[136:139], a[88:91], v[96:99]
    ds_read_b64_tr_b16 v[154:155], v30 offset:25600
    ds_read_b64_tr_b16 v[156:157], v31 offset:24576
    v_mfma_f32_16x16x32_bf16 v[100:103], v[136:139], a[92:95], v[100:103]
    ds_read_b64_tr_b16 v[158:159], v31 offset:25600
    s_waitcnt lgkmcnt(8)
    v_mfma_f32_16x16x32_bf16 v[112:115], v[140:143], a[88:91], v[112:115]
    v_mfma_f32_16x16x32_bf16 v[116:119], v[140:143], a[92:95], v[116:119]
    buffer_load_dwordx4 a[124:127], v1, s[64:67], s41 offen offset:3072 sc1
    s_waitcnt lgkmcnt(0)
    s_barrier
    v_mfma_f32_16x16x32_bf16 v[72:75], v[144:147], a[88:91], v[72:75]
    ds_read_b64_tr_b16 v[132:133], v53 offset:32768
    ds_read_b64_tr_b16 v[134:135], v53 offset:33792
    v_mfma_f32_16x16x32_bf16 v[76:79], v[144:147], a[92:95], v[76:79]
    ds_read_b64_tr_b16 v[136:137], v54 offset:32768
    v_mfma_f32_16x16x32_bf16 v[88:91], v[148:151], a[88:91], v[88:91]
    ds_read_b64_tr_b16 v[138:139], v54 offset:33792
    ds_read_b64_tr_b16 v[140:141], v55 offset:32768
    v_mfma_f32_16x16x32_bf16 v[92:95], v[148:151], a[92:95], v[92:95]
    s_bfe_u32 s30, s29, 0x30010
    s_lshl_b32 s30, s30, 13
    s_add_u32 s41, s69, s30
    buffer_load_dwordx4 a[128:131], v1, s[64:67], s41 offen offset:0 sc1
    v_mfma_f32_16x16x32_bf16 v[104:107], v[152:155], a[88:91], v[104:107]
    ds_read_b64_tr_b16 v[142:143], v55 offset:33792
    v_mfma_f32_16x16x32_bf16 v[108:111], v[152:155], a[92:95], v[108:111]
    v_mfma_f32_16x16x32_bf16 v[120:123], v[156:159], a[88:91], v[120:123]
    v_mfma_f32_16x16x32_bf16 v[124:127], v[156:159], a[92:95], v[124:127]
    buffer_load_dwordx4 a[132:135], v1, s[64:67], s41 offen offset:1024 sc1
    s_waitcnt vmcnt(16)
    s_waitcnt lgkmcnt(4)
    v_mfma_f32_16x16x32_bf16 v[80:83], v[132:135], a[96:99], v[80:83]
    ds_read_b64_tr_b16 v[148:149], v29 offset:32768
    ds_read_b64_tr_b16 v[150:151], v29 offset:33792
    v_mfma_f32_16x16x32_bf16 v[84:87], v[132:135], a[100:103], v[84:87]
    buffer_load_dwordx4 a[136:139], v1, s[64:67], s41 offen offset:2048 sc1
    s_waitcnt lgkmcnt(4)
    v_mfma_f32_16x16x32_bf16 v[96:99], v[136:139], a[96:99], v[96:99]
    ds_read_b64_tr_b16 v[152:153], v30 offset:32768
    ds_read_b64_tr_b16 v[154:155], v30 offset:33792
    v_mfma_f32_16x16x32_bf16 v[100:103], v[136:139], a[100:103], v[100:103]
    ds_read_b64_tr_b16 v[156:157], v31 offset:32768
    s_waitcnt lgkmcnt(5)
    v_mfma_f32_16x16x32_bf16 v[112:115], v[140:143], a[96:99], v[112:115]
    ds_read_b64_tr_b16 v[158:159], v31 offset:33792
    v_mfma_f32_16x16x32_bf16 v[116:119], v[140:143], a[100:103], v[116:119]
    buffer_load_dwordx4 a[140:143], v1, s[64:67], s41 offen offset:3072 sc1
    s_waitcnt lgkmcnt(4)
    v_mfma_f32_16x16x32_bf16 v[88:91], v[148:151], a[96:99], v[88:91]
    ds_read_b64_tr_b16 v[132:133], v53 offset:40960
    ds_read_b64_tr_b16 v[134:135], v53 offset:41984
    v_mfma_f32_16x16x32_bf16 v[92:95], v[148:151], a[100:103], v[92:95]
    s_add_u32 s41, s41, 4096
    buffer_load_dwordx4 a[144:147], v1, s[64:67], s41 offen offset:0 sc1
    s_waitcnt lgkmcnt(4)
    v_mfma_f32_16x16x32_bf16 v[104:107], v[152:155], a[96:99], v[104:107]
    ds_read_b64_tr_b16 v[136:137], v54 offset:40960
    ds_read_b64_tr_b16 v[138:139], v54 offset:41984
    v_mfma_f32_16x16x32_bf16 v[108:111], v[152:155], a[100:103], v[108:111]
    ds_read_b64_tr_b16 v[140:141], v55 offset:40960
    s_waitcnt lgkmcnt(5)
    v_mfma_f32_16x16x32_bf16 v[120:123], v[156:159], a[96:99], v[120:123]
    ds_read_b64_tr_b16 v[142:143], v55 offset:41984
    v_mfma_f32_16x16x32_bf16 v[124:127], v[156:159], a[100:103], v[124:127]
    s_bfe_u32 s39, s29, 0x30014
    s_add_u32 m0, s68, 98304
    s_lshl_b32 s40, s39, 18
    buffer_load_dwordx4 v18, s[60:63], s40 offen offset:0  lds
    s_waitcnt vmcnt(18)
    s_waitcnt lgkmcnt(4)
    v_mfma_f32_16x16x32_bf16 v[80:83], v[132:135], a[104:107], v[80:83]
    ds_read_b64_tr_b16 v[148:149], v29 offset:40960
    ds_read_b64_tr_b16 v[150:151], v29 offset:41984
    v_mfma_f32_16x16x32_bf16 v[84:87], v[132:135], a[108:111], v[84:87]
    buffer_load_dwordx4 v19, s[60:63], s40 offen offset:1024  lds
    s_waitcnt lgkmcnt(4)
    v_mfma_f32_16x16x32_bf16 v[96:99], v[136:139], a[104:107], v[96:99]
    ds_read_b64_tr_b16 v[152:153], v30 offset:40960
    ds_read_b64_tr_b16 v[154:155], v30 offset:41984
    v_mfma_f32_16x16x32_bf16 v[100:103], v[136:139], a[108:111], v[100:103]
    ds_read_b64_tr_b16 v[156:157], v31 offset:40960
    s_waitcnt lgkmcnt(5)
    v_mfma_f32_16x16x32_bf16 v[112:115], v[140:143], a[104:107], v[112:115]
    ds_read_b64_tr_b16 v[158:159], v31 offset:41984
    v_mfma_f32_16x16x32_bf16 v[116:119], v[140:143], a[108:111], v[116:119]
    buffer_load_dwordx4 v20, s[60:63], s40 offen offset:2048  lds
    s_waitcnt lgkmcnt(4)
    v_mfma_f32_16x16x32_bf16 v[88:91], v[148:151], a[104:107], v[88:91]
    ds_read_b64_tr_b16 v[132:133], v53 offset:49152
    ds_read_b64_tr_b16 v[134:135], v53 offset:50176
    v_mfma_f32_16x16x32_bf16 v[92:95], v[148:151], a[108:111], v[92:95]
    buffer_load_dwordx4 v21, s[60:63], s40 offen offset:3072  lds
    s_waitcnt lgkmcnt(4)
    v_mfma_f32_16x16x32_bf16 v[104:107], v[152:155], a[104:107], v[104:107]
    ds_read_b64_tr_b16 v[136:137], v54 offset:49152
    ds_read_b64_tr_b16 v[138:139], v54 offset:50176
    v_mfma_f32_16x16x32_bf16 v[108:111], v[152:155], a[108:111], v[108:111]
    ds_read_b64_tr_b16 v[140:141], v55 offset:49152
    s_waitcnt lgkmcnt(5)
    v_mfma_f32_16x16x32_bf16 v[120:123], v[156:159], a[104:107], v[120:123]
    ds_read_b64_tr_b16 v[142:143], v55 offset:50176
    v_mfma_f32_16x16x32_bf16 v[124:127], v[156:159], a[108:111], v[124:127]
    s_add_u32 m0, s68, 102400
    s_add_u32 s40, s40, 32768
    buffer_load_dwordx4 v14, s[60:63], s40 offen offset:0  lds
    s_waitcnt vmcnt(12)
    s_waitcnt lgkmcnt(4)
    v_mfma_f32_16x16x32_bf16 v[80:83], v[132:135], a[112:115], v[80:83]
    ds_read_b64_tr_b16 v[148:149], v29 offset:49152
    ds_read_b64_tr_b16 v[150:151], v29 offset:50176
    v_mfma_f32_16x16x32_bf16 v[84:87], v[132:135], a[116:119], v[84:87]
    buffer_load_dwordx4 v15, s[60:63], s40 offen offset:1024  lds
    s_waitcnt lgkmcnt(4)
    v_mfma_f32_16x16x32_bf16 v[96:99], v[136:139], a[112:115], v[96:99]
    ds_read_b64_tr_b16 v[152:153], v30 offset:49152
    ds_read_b64_tr_b16 v[154:155], v30 offset:50176
    v_mfma_f32_16x16x32_bf16 v[100:103], v[136:139], a[116:119], v[100:103]
    ds_read_b64_tr_b16 v[156:157], v31 offset:49152
    s_waitcnt lgkmcnt(5)
    v_mfma_f32_16x16x32_bf16 v[112:115], v[140:143], a[112:115], v[112:115]
    ds_read_b64_tr_b16 v[158:159], v31 offset:50176
    v_mfma_f32_16x16x32_bf16 v[116:119], v[140:143], a[116:119], v[116:119]
    buffer_load_dwordx4 v16, s[60:63], s40 offen offset:2048  lds
    s_waitcnt lgkmcnt(4)
    v_mfma_f32_16x16x32_bf16 v[88:91], v[148:151], a[112:115], v[88:91]
    ds_read_b64_tr_b16 v[132:133], v53 offset:57344
    ds_read_b64_tr_b16 v[134:135], v53 offset:58368
    v_mfma_f32_16x16x32_bf16 v[92:95], v[148:151], a[116:119], v[92:95]
    buffer_load_dwordx4 v17, s[60:63], s40 offen offset:3072  lds
    s_waitcnt lgkmcnt(4)
    v_mfma_f32_16x16x32_bf16 v[104:107], v[152:155], a[112:115], v[104:107]
    ds_read_b64_tr_b16 v[136:137], v54 offset:57344
    ds_read_b64_tr_b16 v[138:139], v54 offset:58368
    v_mfma_f32_16x16x32_bf16 v[108:111], v[152:155], a[116:119], v[108:111]
    ds_read_b64_tr_b16 v[140:141], v55 offset:57344
    s_waitcnt lgkmcnt(5)
    v_mfma_f32_16x16x32_bf16 v[120:123], v[156:159], a[112:115], v[120:123]
    ds_read_b64_tr_b16 v[142:143], v55 offset:58368
    v_mfma_f32_16x16x32_bf16 v[124:127], v[156:159], a[116:119], v[124:127]
    buffer_load_dwordx4 a[148:151], v1, s[64:67], s41 offen offset:1024 sc1
    s_waitcnt vmcnt(14)
    s_waitcnt lgkmcnt(4)
    v_mfma_f32_16x16x32_bf16 v[80:83], v[132:135], a[120:123], v[80:83]
    ds_read_b64_tr_b16 v[148:149], v29 offset:57344
    ds_read_b64_tr_b16 v[150:151], v29 offset:58368
    v_mfma_f32_16x16x32_bf16 v[84:87], v[132:135], a[124:127], v[84:87]
    buffer_load_dwordx4 a[152:155], v1, s[64:67], s41 offen offset:2048 sc1
    s_waitcnt lgkmcnt(4)
    v_mfma_f32_16x16x32_bf16 v[96:99], v[136:139], a[120:123], v[96:99]
    ds_read_b64_tr_b16 v[152:153], v30 offset:57344
    ds_read_b64_tr_b16 v[154:155], v30 offset:58368
    v_mfma_f32_16x16x32_bf16 v[100:103], v[136:139], a[124:127], v[100:103]
    ds_read_b64_tr_b16 v[156:157], v31 offset:57344
    s_waitcnt lgkmcnt(5)
    v_mfma_f32_16x16x32_bf16 v[112:115], v[140:143], a[120:123], v[112:115]
    ds_read_b64_tr_b16 v[158:159], v31 offset:58368
    v_mfma_f32_16x16x32_bf16 v[116:119], v[140:143], a[124:127], v[116:119]
    buffer_load_dwordx4 a[156:159], v1, s[64:67], s41 offen offset:3072 sc1
    s_waitcnt lgkmcnt(0)
    s_barrier
    v_mfma_f32_16x16x32_bf16 v[88:91], v[148:151], a[120:123], v[88:91]
    ds_read_b64_tr_b16 v[132:133], v57 offset:0
    ds_read_b64_tr_b16 v[134:135], v57 offset:1024
    v_mfma_f32_16x16x32_bf16 v[92:95], v[148:151], a[124:127], v[92:95]
    s_bfe_u32 s30, s29, 0x30014
    s_lshl_b32 s30, s30, 13
    s_add_u32 s41, s69, s30
    buffer_load_dwordx4 a[160:163], v1, s[64:67], s41 offen offset:0 sc1
    v_mfma_f32_16x16x32_bf16 v[104:107], v[152:155], a[120:123], v[104:107]
    ds_read_b64_tr_b16 v[136:137], v58 offset:0
    ds_read_b64_tr_b16 v[138:139], v58 offset:1024
    v_mfma_f32_16x16x32_bf16 v[108:111], v[152:155], a[124:127], v[108:111]
    ds_read_b64_tr_b16 v[140:141], v59 offset:0
    v_mfma_f32_16x16x32_bf16 v[120:123], v[156:159], a[120:123], v[120:123]
    ds_read_b64_tr_b16 v[142:143], v59 offset:1024
    v_mfma_f32_16x16x32_bf16 v[124:127], v[156:159], a[124:127], v[124:127]
    buffer_load_dwordx4 a[164:167], v1, s[64:67], s41 offen offset:1024 sc1
    s_waitcnt vmcnt(16)
    s_waitcnt lgkmcnt(4)
    v_mfma_f32_16x16x32_bf16 v[80:83], v[132:135], a[128:131], v[80:83]
    ds_read_b64_tr_b16 v[148:149], v33 offset:0
    ds_read_b64_tr_b16 v[150:151], v33 offset:1024
    v_mfma_f32_16x16x32_bf16 v[84:87], v[132:135], a[132:135], v[84:87]
    buffer_load_dwordx4 a[168:171], v1, s[64:67], s41 offen offset:2048 sc1
    s_waitcnt lgkmcnt(4)
    v_mfma_f32_16x16x32_bf16 v[96:99], v[136:139], a[128:131], v[96:99]
    ds_read_b64_tr_b16 v[152:153], v34 offset:0
    ds_read_b64_tr_b16 v[154:155], v34 offset:1024
    v_mfma_f32_16x16x32_bf16 v[100:103], v[136:139], a[132:135], v[100:103]
    ds_read_b64_tr_b16 v[156:157], v35 offset:0
    s_waitcnt lgkmcnt(5)
    v_mfma_f32_16x16x32_bf16 v[112:115], v[140:143], a[128:131], v[112:115]
    ds_read_b64_tr_b16 v[158:159], v35 offset:1024
    v_mfma_f32_16x16x32_bf16 v[116:119], v[140:143], a[132:135], v[116:119]
    buffer_load_dwordx4 a[172:175], v1, s[64:67], s41 offen offset:3072 sc1
    s_waitcnt lgkmcnt(4)
    v_mfma_f32_16x16x32_bf16 v[88:91], v[148:151], a[128:131], v[88:91]
    ds_read_b64_tr_b16 v[132:133], v57 offset:8192
    ds_read_b64_tr_b16 v[134:135], v57 offset:9216
    v_mfma_f32_16x16x32_bf16 v[92:95], v[148:151], a[132:135], v[92:95]
    s_add_u32 s41, s41, 4096
    buffer_load_dwordx4 a[176:179], v1, s[64:67], s41 offen offset:0 sc1
    s_waitcnt lgkmcnt(4)
    v_mfma_f32_16x16x32_bf16 v[104:107], v[152:155], a[128:131], v[104:107]
    ds_read_b64_tr_b16 v[136:137], v58 offset:8192
    ds_read_b64_tr_b16 v[138:139], v58 offset:9216
    v_mfma_f32_16x16x32_bf16 v[108:111], v[152:155], a[132:135], v[108:111]
    ds_read_b64_tr_b16 v[140:141], v59 offset:8192
    s_waitcnt lgkmcnt(5)
    v_mfma_f32_16x16x32_bf16 v[120:123], v[156:159], a[128:131], v[120:123]
    ds_read_b64_tr_b16 v[142:143], v59 offset:9216
    v_mfma_f32_16x16x32_bf16 v[124:127], v[156:159], a[132:135], v[124:127]
    s_bfe_u32 s39, s29, 0x30018
    s_add_u32 m0, s68, 131072
    s_lshl_b32 s40, s39, 18
    buffer_load_dwordx4 v18, s[60:63], s40 offen offset:0  lds
    s_waitcnt vmcnt(18)
    s_waitcnt lgkmcnt(4)
    v_mfma_f32_16x16x32_bf16 v[80:83], v[132:135], a[136:139], v[80:83]
    ds_read_b64_tr_b16 v[148:149], v33 offset:8192
    ds_read_b64_tr_b16 v[150:151], v33 offset:9216
    v_mfma_f32_16x16x32_bf16 v[84:87], v[132:135], a[140:143], v[84:87]
    buffer_load_dwordx4 v19, s[60:63], s40 offen offset:1024  lds
    s_waitcnt lgkmcnt(4)
    v_mfma_f32_16x16x32_bf16 v[96:99], v[136:139], a[136:139], v[96:99]
    ds_read_b64_tr_b16 v[152:153], v34 offset:8192
    ds_read_b64_tr_b16 v[154:155], v34 offset:9216
    v_mfma_f32_16x16x32_bf16 v[100:103], v[136:139], a[140:143], v[100:103]
    ds_read_b64_tr_b16 v[156:157], v35 offset:8192
    s_waitcnt lgkmcnt(5)
    v_mfma_f32_16x16x32_bf16 v[112:115], v[140:143], a[136:139], v[112:115]
    ds_read_b64_tr_b16 v[158:159], v35 offset:9216
    v_mfma_f32_16x16x32_bf16 v[116:119], v[140:143], a[140:143], v[116:119]
    buffer_load_dwordx4 v20, s[60:63], s40 offen offset:2048  lds
    s_waitcnt lgkmcnt(4)
    v_mfma_f32_16x16x32_bf16 v[88:91], v[148:151], a[136:139], v[88:91]
    ds_read_b64_tr_b16 v[132:133], v57 offset:16384
    ds_read_b64_tr_b16 v[134:135], v57 offset:17408
    v_mfma_f32_16x16x32_bf16 v[92:95], v[148:151], a[140:143], v[92:95]
    buffer_load_dwordx4 v21, s[60:63], s40 offen offset:3072  lds
    s_waitcnt lgkmcnt(4)
    v_mfma_f32_16x16x32_bf16 v[104:107], v[152:155], a[136:139], v[104:107]
    ds_read_b64_tr_b16 v[136:137], v58 offset:16384
    ds_read_b64_tr_b16 v[138:139], v58 offset:17408
    v_mfma_f32_16x16x32_bf16 v[108:111], v[152:155], a[140:143], v[108:111]
    ds_read_b64_tr_b16 v[140:141], v59 offset:16384
    s_waitcnt lgkmcnt(5)
    v_mfma_f32_16x16x32_bf16 v[120:123], v[156:159], a[136:139], v[120:123]
    ds_read_b64_tr_b16 v[142:143], v59 offset:17408
    v_mfma_f32_16x16x32_bf16 v[124:127], v[156:159], a[140:143], v[124:127]
    s_add_u32 m0, s68, 135168
    s_add_u32 s40, s40, 32768
    buffer_load_dwordx4 v14, s[60:63], s40 offen offset:0  lds
    s_waitcnt vmcnt(12)
    s_waitcnt lgkmcnt(4)
    v_mfma_f32_16x16x32_bf16 v[80:83], v[132:135], a[144:147], v[80:83]
    ds_read_b64_tr_b16 v[148:149], v33 offset:16384
    ds_read_b64_tr_b16 v[150:151], v33 offset:17408
    v_mfma_f32_16x16x32_bf16 v[84:87], v[132:135], a[148:151], v[84:87]
    buffer_load_dwordx4 v15, s[60:63], s40 offen offset:1024  lds
    s_waitcnt lgkmcnt(4)
    v_mfma_f32_16x16x32_bf16 v[96:99], v[136:139], a[144:147], v[96:99]
    ds_read_b64_tr_b16 v[152:153], v34 offset:16384
    ds_read_b64_tr_b16 v[154:155], v34 offset:17408
    v_mfma_f32_16x16x32_bf16 v[100:103], v[136:139], a[148:151], v[100:103]
    ds_read_b64_tr_b16 v[156:157], v35 offset:16384
    s_waitcnt lgkmcnt(5)
    v_mfma_f32_16x16x32_bf16 v[112:115], v[140:143], a[144:147], v[112:115]
    ds_read_b64_tr_b16 v[158:159], v35 offset:17408
    v_mfma_f32_16x16x32_bf16 v[116:119], v[140:143], a[148:151], v[116:119]
    buffer_load_dwordx4 v16, s[60:63], s40 offen offset:2048  lds
    s_waitcnt lgkmcnt(4)
    v_mfma_f32_16x16x32_bf16 v[88:91], v[148:151], a[144:147], v[88:91]
    ds_read_b64_tr_b16 v[132:133], v57 offset:24576
    ds_read_b64_tr_b16 v[134:135], v57 offset:25600
    v_mfma_f32_16x16x32_bf16 v[92:95], v[148:151], a[148:151], v[92:95]
    buffer_load_dwordx4 v17, s[60:63], s40 offen offset:3072  lds
    s_waitcnt lgkmcnt(4)
    v_mfma_f32_16x16x32_bf16 v[104:107], v[152:155], a[144:147], v[104:107]
    ds_read_b64_tr_b16 v[136:137], v58 offset:24576
    ds_read_b64_tr_b16 v[138:139], v58 offset:25600
    v_mfma_f32_16x16x32_bf16 v[108:111], v[152:155], a[148:151], v[108:111]
    ds_read_b64_tr_b16 v[140:141], v59 offset:24576
    s_waitcnt lgkmcnt(5)
    v_mfma_f32_16x16x32_bf16 v[120:123], v[156:159], a[144:147], v[120:123]
    ds_read_b64_tr_b16 v[142:143], v59 offset:25600
    v_mfma_f32_16x16x32_bf16 v[124:127], v[156:159], a[148:151], v[124:127]
    buffer_load_dwordx4 a[180:183], v1, s[64:67], s41 offen offset:1024 sc1
    s_waitcnt vmcnt(14)
    s_waitcnt lgkmcnt(4)
    v_mfma_f32_16x16x32_bf16 v[80:83], v[132:135], a[152:155], v[80:83]
    ds_read_b64_tr_b16 v[148:149], v33 offset:24576
    ds_read_b64_tr_b16 v[150:151], v33 offset:25600
    v_mfma_f32_16x16x32_bf16 v[84:87], v[132:135], a[156:159], v[84:87]
    buffer_load_dwordx4 a[184:187], v1, s[64:67], s41 offen offset:2048 sc1
    s_waitcnt lgkmcnt(4)
    v_mfma_f32_16x16x32_bf16 v[96:99], v[136:139], a[152:155], v[96:99]
    ds_read_b64_tr_b16 v[152:153], v34 offset:24576
    ds_read_b64_tr_b16 v[154:155], v34 offset:25600
    v_mfma_f32_16x16x32_bf16 v[100:103], v[136:139], a[156:159], v[100:103]
    ds_read_b64_tr_b16 v[156:157], v35 offset:24576
    s_waitcnt lgkmcnt(5)
    v_mfma_f32_16x16x32_bf16 v[112:115], v[140:143], a[152:155], v[112:115]
    ds_read_b64_tr_b16 v[158:159], v35 offset:25600
    v_mfma_f32_16x16x32_bf16 v[116:119], v[140:143], a[156:159], v[116:119]
    buffer_load_dwordx4 a[188:191], v1, s[64:67], s41 offen offset:3072 sc1
    s_waitcnt lgkmcnt(0)
    s_barrier
    v_mfma_f32_16x16x32_bf16 v[88:91], v[148:151], a[152:155], v[88:91]
    ds_read_b64_tr_b16 v[132:133], v57 offset:32768
    ds_read_b64_tr_b16 v[134:135], v57 offset:33792
    v_mfma_f32_16x16x32_bf16 v[92:95], v[148:151], a[156:159], v[92:95]
    s_bfe_u32 s30, s29, 0x30018
    s_lshl_b32 s30, s30, 13
    s_add_u32 s41, s69, s30
    buffer_load_dwordx4 a[192:195], v1, s[64:67], s41 offen offset:0 sc1
    v_mfma_f32_16x16x32_bf16 v[104:107], v[152:155], a[152:155], v[104:107]
    ds_read_b64_tr_b16 v[136:137], v58 offset:32768
    ds_read_b64_tr_b16 v[138:139], v58 offset:33792
    v_mfma_f32_16x16x32_bf16 v[108:111], v[152:155], a[156:159], v[108:111]
    ds_read_b64_tr_b16 v[140:141], v59 offset:32768
    v_mfma_f32_16x16x32_bf16 v[120:123], v[156:159], a[152:155], v[120:123]
    ds_read_b64_tr_b16 v[142:143], v59 offset:33792
    v_mfma_f32_16x16x32_bf16 v[124:127], v[156:159], a[156:159], v[124:127]
    buffer_load_dwordx4 a[196:199], v1, s[64:67], s41 offen offset:1024 sc1
    s_waitcnt vmcnt(16)
    s_waitcnt lgkmcnt(4)
    v_mfma_f32_16x16x32_bf16 v[80:83], v[132:135], a[160:163], v[80:83]
    ds_read_b64_tr_b16 v[148:149], v33 offset:32768
    ds_read_b64_tr_b16 v[150:151], v33 offset:33792
    v_mfma_f32_16x16x32_bf16 v[84:87], v[132:135], a[164:167], v[84:87]
    buffer_load_dwordx4 a[200:203], v1, s[64:67], s41 offen offset:2048 sc1
    s_waitcnt lgkmcnt(4)
    v_mfma_f32_16x16x32_bf16 v[96:99], v[136:139], a[160:163], v[96:99]
    ds_read_b64_tr_b16 v[152:153], v34 offset:32768
    ds_read_b64_tr_b16 v[154:155], v34 offset:33792
    v_mfma_f32_16x16x32_bf16 v[100:103], v[136:139], a[164:167], v[100:103]
    ds_read_b64_tr_b16 v[156:157], v35 offset:32768
    s_waitcnt lgkmcnt(5)
    v_mfma_f32_16x16x32_bf16 v[112:115], v[140:143], a[160:163], v[112:115]
    ds_read_b64_tr_b16 v[158:159], v35 offset:33792
    v_mfma_f32_16x16x32_bf16 v[116:119], v[140:143], a[164:167], v[116:119]
    buffer_load_dwordx4 a[204:207], v1, s[64:67], s41 offen offset:3072 sc1
    s_waitcnt lgkmcnt(4)
    v_mfma_f32_16x16x32_bf16 v[88:91], v[148:151], a[160:163], v[88:91]
    ds_read_b64_tr_b16 v[132:133], v57 offset:40960
    ds_read_b64_tr_b16 v[134:135], v57 offset:41984
    v_mfma_f32_16x16x32_bf16 v[92:95], v[148:151], a[164:167], v[92:95]
    s_add_u32 s41, s41, 4096
    buffer_load_dwordx4 a[208:211], v1, s[64:67], s41 offen offset:0 sc1
    s_waitcnt lgkmcnt(4)
    v_mfma_f32_16x16x32_bf16 v[104:107], v[152:155], a[160:163], v[104:107]
    ds_read_b64_tr_b16 v[136:137], v58 offset:40960
    ds_read_b64_tr_b16 v[138:139], v58 offset:41984
    v_mfma_f32_16x16x32_bf16 v[108:111], v[152:155], a[164:167], v[108:111]
    ds_read_b64_tr_b16 v[140:141], v59 offset:40960
    s_waitcnt lgkmcnt(5)
    v_mfma_f32_16x16x32_bf16 v[120:123], v[156:159], a[160:163], v[120:123]
    ds_read_b64_tr_b16 v[142:143], v59 offset:41984
    v_mfma_f32_16x16x32_bf16 v[124:127], v[156:159], a[164:167], v[124:127]
    s_bfe_u32 s39, s29, 0x3001c
    s_add_u32 m0, s68, 0
    s_lshl_b32 s40, s39, 18
    buffer_load_dwordx4 v18, s[60:63], s40 offen offset:0  lds
    s_waitcnt vmcnt(18)
    s_waitcnt lgkmcnt(4)
    v_mfma_f32_16x16x32_bf16 v[80:83], v[132:135], a[168:171], v[80:83]
    ds_read_b64_tr_b16 v[148:149], v33 offset:40960
    ds_read_b64_tr_b16 v[150:151], v33 offset:41984
    v_mfma_f32_16x16x32_bf16 v[84:87], v[132:135], a[172:175], v[84:87]
    buffer_load_dwordx4 v19, s[60:63], s40 offen offset:1024  lds
    s_waitcnt lgkmcnt(4)
    v_mfma_f32_16x16x32_bf16 v[96:99], v[136:139], a[168:171], v[96:99]
    ds_read_b64_tr_b16 v[152:153], v34 offset:40960
    ds_read_b64_tr_b16 v[154:155], v34 offset:41984
    v_mfma_f32_16x16x32_bf16 v[100:103], v[136:139], a[172:175], v[100:103]
    ds_read_b64_tr_b16 v[156:157], v35 offset:40960
    s_waitcnt lgkmcnt(5)
    v_mfma_f32_16x16x32_bf16 v[112:115], v[140:143], a[168:171], v[112:115]
    ds_read_b64_tr_b16 v[158:159], v35 offset:41984
    v_mfma_f32_16x16x32_bf16 v[116:119], v[140:143], a[172:175], v[116:119]
    buffer_load_dwordx4 v20, s[60:63], s40 offen offset:2048  lds
    s_waitcnt lgkmcnt(4)
    v_mfma_f32_16x16x32_bf16 v[88:91], v[148:151], a[168:171], v[88:91]
    ds_read_b64_tr_b16 v[132:133], v57 offset:49152
    ds_read_b64_tr_b16 v[134:135], v57 offset:50176
    v_mfma_f32_16x16x32_bf16 v[92:95], v[148:151], a[172:175], v[92:95]
    buffer_load_dwordx4 v21, s[60:63], s40 offen offset:3072  lds
    s_waitcnt lgkmcnt(4)
    v_mfma_f32_16x16x32_bf16 v[104:107], v[152:155], a[168:171], v[104:107]
    ds_read_b64_tr_b16 v[136:137], v58 offset:49152
    ds_read_b64_tr_b16 v[138:139], v58 offset:50176
    v_mfma_f32_16x16x32_bf16 v[108:111], v[152:155], a[172:175], v[108:111]
    ds_read_b64_tr_b16 v[140:141], v59 offset:49152
    s_waitcnt lgkmcnt(5)
    v_mfma_f32_16x16x32_bf16 v[120:123], v[156:159], a[168:171], v[120:123]
    ds_read_b64_tr_b16 v[142:143], v59 offset:50176
    v_mfma_f32_16x16x32_bf16 v[124:127], v[156:159], a[172:175], v[124:127]
    s_add_u32 m0, s68, 4096
    s_add_u32 s40, s40, 32768
    buffer_load_dwordx4 v14, s[60:63], s40 offen offset:0  lds
    s_waitcnt vmcnt(12)
    s_waitcnt lgkmcnt(4)
    v_mfma_f32_16x16x32_bf16 v[80:83], v[132:135], a[176:179], v[80:83]
    ds_read_b64_tr_b16 v[148:149], v33 offset:49152
    ds_read_b64_tr_b16 v[150:151], v33 offset:50176
    v_mfma_f32_16x16x32_bf16 v[84:87], v[132:135], a[180:183], v[84:87]
    buffer_load_dwordx4 v15, s[60:63], s40 offen offset:1024  lds
    s_waitcnt lgkmcnt(4)
    v_mfma_f32_16x16x32_bf16 v[96:99], v[136:139], a[176:179], v[96:99]
    ds_read_b64_tr_b16 v[152:153], v34 offset:49152
    ds_read_b64_tr_b16 v[154:155], v34 offset:50176
    v_mfma_f32_16x16x32_bf16 v[100:103], v[136:139], a[180:183], v[100:103]
    ds_read_b64_tr_b16 v[156:157], v35 offset:49152
    s_waitcnt lgkmcnt(5)
    v_mfma_f32_16x16x32_bf16 v[112:115], v[140:143], a[176:179], v[112:115]
    ds_read_b64_tr_b16 v[158:159], v35 offset:50176
    v_mfma_f32_16x16x32_bf16 v[116:119], v[140:143], a[180:183], v[116:119]
    buffer_load_dwordx4 v16, s[60:63], s40 offen offset:2048  lds
    s_waitcnt lgkmcnt(4)
    v_mfma_f32_16x16x32_bf16 v[88:91], v[148:151], a[176:179], v[88:91]
    ds_read_b64_tr_b16 v[132:133], v57 offset:57344
    ds_read_b64_tr_b16 v[134:135], v57 offset:58368
    v_mfma_f32_16x16x32_bf16 v[92:95], v[148:151], a[180:183], v[92:95]
    buffer_load_dwordx4 v17, s[60:63], s40 offen offset:3072  lds
    s_waitcnt lgkmcnt(4)
    v_mfma_f32_16x16x32_bf16 v[104:107], v[152:155], a[176:179], v[104:107]
    ds_read_b64_tr_b16 v[136:137], v58 offset:57344
    ds_read_b64_tr_b16 v[138:139], v58 offset:58368
    v_mfma_f32_16x16x32_bf16 v[108:111], v[152:155], a[180:183], v[108:111]
    ds_read_b64_tr_b16 v[140:141], v59 offset:57344
    s_waitcnt lgkmcnt(5)
    v_mfma_f32_16x16x32_bf16 v[120:123], v[156:159], a[176:179], v[120:123]
    ds_read_b64_tr_b16 v[142:143], v59 offset:58368
    v_mfma_f32_16x16x32_bf16 v[124:127], v[156:159], a[180:183], v[124:127]
    buffer_load_dwordx4 a[212:215], v1, s[64:67], s41 offen offset:1024 sc1
    s_waitcnt vmcnt(14)
    s_waitcnt lgkmcnt(4)
    v_mfma_f32_16x16x32_bf16 v[80:83], v[132:135], a[184:187], v[80:83]
    ds_read_b64_tr_b16 v[148:149], v33 offset:57344
    ds_read_b64_tr_b16 v[150:151], v33 offset:58368
    v_mfma_f32_16x16x32_bf16 v[84:87], v[132:135], a[188:191], v[84:87]
    buffer_load_dwordx4 a[216:219], v1, s[64:67], s41 offen offset:2048 sc1
    s_waitcnt lgkmcnt(4)
    v_mfma_f32_16x16x32_bf16 v[96:99], v[136:139], a[184:187], v[96:99]
    ds_read_b64_tr_b16 v[152:153], v34 offset:57344
    ds_read_b64_tr_b16 v[154:155], v34 offset:58368
    v_mfma_f32_16x16x32_bf16 v[100:103], v[136:139], a[188:191], v[100:103]
    ds_read_b64_tr_b16 v[156:157], v35 offset:57344
    s_waitcnt lgkmcnt(5)
    v_mfma_f32_16x16x32_bf16 v[112:115], v[140:143], a[184:187], v[112:115]
    ds_read_b64_tr_b16 v[158:159], v35 offset:58368
    v_mfma_f32_16x16x32_bf16 v[116:119], v[140:143], a[188:191], v[116:119]
    s_waitcnt lgkmcnt(0)
    s_barrier
    v_mfma_f32_16x16x32_bf16 v[88:91], v[148:151], a[184:187], v[88:91]
    ds_read_b64_tr_b16 v[132:133], v61 offset:0
    ds_read_b64_tr_b16 v[134:135], v61 offset:1024
    v_mfma_f32_16x16x32_bf16 v[92:95], v[148:151], a[188:191], v[92:95]
    buffer_load_dwordx4 a[220:223], v1, s[64:67], s41 offen offset:3072 sc1
    v_mfma_f32_16x16x32_bf16 v[104:107], v[152:155], a[184:187], v[104:107]
    ds_read_b64_tr_b16 v[136:137], v62 offset:0
    ds_read_b64_tr_b16 v[138:139], v62 offset:1024
    v_mfma_f32_16x16x32_bf16 v[108:111], v[152:155], a[188:191], v[108:111]
    ds_read_b64_tr_b16 v[140:141], v63 offset:0
    v_mfma_f32_16x16x32_bf16 v[120:123], v[156:159], a[184:187], v[120:123]
    ds_read_b64_tr_b16 v[142:143], v63 offset:1024
    v_mfma_f32_16x16x32_bf16 v[124:127], v[156:159], a[188:191], v[124:127]
    s_waitcnt vmcnt(14)
    s_waitcnt lgkmcnt(4)
    v_mfma_f32_16x16x32_bf16 v[80:83], v[132:135], a[192:195], v[80:83]
    ds_read_b64_tr_b16 v[148:149], v37 offset:0
    ds_read_b64_tr_b16 v[150:151], v37 offset:1024
    v_mfma_f32_16x16x32_bf16 v[84:87], v[132:135], a[196:199], v[84:87]
    s_bfe_u32 s30, s29, 0x3001c
    s_lshl_b32 s30, s30, 13
    s_add_u32 s41, s69, s30
    buffer_load_dwordx4 a[224:227], v1, s[64:67], s41 offen offset:0 sc1
    s_waitcnt lgkmcnt(4)
    v_mfma_f32_16x16x32_bf16 v[96:99], v[136:139], a[192:195], v[96:99]
    ds_read_b64_tr_b16 v[152:153], v38 offset:0
    ds_read_b64_tr_b16 v[154:155], v38 offset:1024
    v_mfma_f32_16x16x32_bf16 v[100:103], v[136:139], a[196:199], v[100:103]
    ds_read_b64_tr_b16 v[156:157], v39 offset:0
    s_waitcnt lgkmcnt(5)
    v_mfma_f32_16x16x32_bf16 v[112:115], v[140:143], a[192:195], v[112:115]
    ds_read_b64_tr_b16 v[158:159], v39 offset:1024
    v_mfma_f32_16x16x32_bf16 v[116:119], v[140:143], a[196:199], v[116:119]
    s_waitcnt lgkmcnt(4)
    v_mfma_f32_16x16x32_bf16 v[88:91], v[148:151], a[192:195], v[88:91]
    ds_read_b64_tr_b16 v[132:133], v61 offset:8192
    ds_read_b64_tr_b16 v[134:135], v61 offset:9216
    v_mfma_f32_16x16x32_bf16 v[92:95], v[148:151], a[196:199], v[92:95]
    buffer_load_dwordx4 a[228:231], v1, s[64:67], s41 offen offset:1024 sc1
    s_waitcnt lgkmcnt(4)
    v_mfma_f32_16x16x32_bf16 v[104:107], v[152:155], a[192:195], v[104:107]
    ds_read_b64_tr_b16 v[136:137], v62 offset:8192
    ds_read_b64_tr_b16 v[138:139], v62 offset:9216
    v_mfma_f32_16x16x32_bf16 v[108:111], v[152:155], a[196:199], v[108:111]
    ds_read_b64_tr_b16 v[140:141], v63 offset:8192
    s_waitcnt lgkmcnt(5)
    v_mfma_f32_16x16x32_bf16 v[120:123], v[156:159], a[192:195], v[120:123]
    ds_read_b64_tr_b16 v[142:143], v63 offset:9216
    v_mfma_f32_16x16x32_bf16 v[124:127], v[156:159], a[196:199], v[124:127]
    s_waitcnt vmcnt(14)
    s_waitcnt lgkmcnt(4)
    v_mfma_f32_16x16x32_bf16 v[80:83], v[132:135], a[200:203], v[80:83]
    ds_read_b64_tr_b16 v[148:149], v37 offset:8192
    ds_read_b64_tr_b16 v[150:151], v37 offset:9216
    v_mfma_f32_16x16x32_bf16 v[84:87], v[132:135], a[204:207], v[84:87]
    buffer_load_dwordx4 a[232:235], v1, s[64:67], s41 offen offset:2048 sc1
    s_waitcnt lgkmcnt(4)
    v_mfma_f32_16x16x32_bf16 v[96:99], v[136:139], a[200:203], v[96:99]
    ds_read_b64_tr_b16 v[152:153], v38 offset:8192
    ds_read_b64_tr_b16 v[154:155], v38 offset:9216
    v_mfma_f32_16x16x32_bf16 v[100:103], v[136:139], a[204:207], v[100:103]
    ds_read_b64_tr_b16 v[156:157], v39 offset:8192
    s_waitcnt lgkmcnt(5)
    v_mfma_f32_16x16x32_bf16 v[112:115], v[140:143], a[200:203], v[112:115]
    ds_read_b64_tr_b16 v[158:159], v39 offset:9216
    v_mfma_f32_16x16x32_bf16 v[116:119], v[140:143], a[204:207], v[116:119]
    s_waitcnt lgkmcnt(4)
    v_mfma_f32_16x16x32_bf16 v[88:91], v[148:151], a[200:203], v[88:91]
    ds_read_b64_tr_b16 v[132:133], v61 offset:16384
    ds_read_b64_tr_b16 v[134:135], v61 offset:17408
    v_mfma_f32_16x16x32_bf16 v[92:95], v[148:151], a[204:207], v[92:95]
    buffer_load_dwordx4 a[236:239], v1, s[64:67], s41 offen offset:3072 sc1
    s_waitcnt lgkmcnt(4)
    v_mfma_f32_16x16x32_bf16 v[104:107], v[152:155], a[200:203], v[104:107]
    ds_read_b64_tr_b16 v[136:137], v62 offset:16384
    ds_read_b64_tr_b16 v[138:139], v62 offset:17408
    v_mfma_f32_16x16x32_bf16 v[108:111], v[152:155], a[204:207], v[108:111]
    ds_read_b64_tr_b16 v[140:141], v63 offset:16384
    s_waitcnt lgkmcnt(5)
    v_mfma_f32_16x16x32_bf16 v[120:123], v[156:159], a[200:203], v[120:123]
    ds_read_b64_tr_b16 v[142:143], v63 offset:17408
    v_mfma_f32_16x16x32_bf16 v[124:127], v[156:159], a[204:207], v[124:127]
    s_waitcnt vmcnt(6)
    s_waitcnt lgkmcnt(4)
    v_mfma_f32_16x16x32_bf16 v[80:83], v[132:135], a[208:211], v[80:83]
    ds_read_b64_tr_b16 v[148:149], v37 offset:16384
    ds_read_b64_tr_b16 v[150:151], v37 offset:17408
    v_mfma_f32_16x16x32_bf16 v[84:87], v[132:135], a[212:215], v[84:87]
    s_add_u32 s41, s41, 4096
    buffer_load_dwordx4 a[240:243], v1, s[64:67], s41 offen offset:0 sc1
    s_waitcnt lgkmcnt(4)
    v_mfma_f32_16x16x32_bf16 v[96:99], v[136:139], a[208:211], v[96:99]
    ds_read_b64_tr_b16 v[152:153], v38 offset:16384
    ds_read_b64_tr_b16 v[154:155], v38 offset:17408
    v_mfma_f32_16x16x32_bf16 v[100:103], v[136:139], a[212:215], v[100:103]
    ds_read_b64_tr_b16 v[156:157], v39 offset:16384
    s_waitcnt lgkmcnt(5)
    v_mfma_f32_16x16x32_bf16 v[112:115], v[140:143], a[208:211], v[112:115]
    ds_read_b64_tr_b16 v[158:159], v39 offset:17408
    v_mfma_f32_16x16x32_bf16 v[116:119], v[140:143], a[212:215], v[116:119]
    s_waitcnt lgkmcnt(4)
    v_mfma_f32_16x16x32_bf16 v[88:91], v[148:151], a[208:211], v[88:91]
    ds_read_b64_tr_b16 v[132:133], v61 offset:24576
    ds_read_b64_tr_b16 v[134:135], v61 offset:25600
    v_mfma_f32_16x16x32_bf16 v[92:95], v[148:151], a[212:215], v[92:95]
    buffer_load_dwordx4 a[244:247], v1, s[64:67], s41 offen offset:1024 sc1
    s_waitcnt lgkmcnt(4)
    v_mfma_f32_16x16x32_bf16 v[104:107], v[152:155], a[208:211], v[104:107]
    ds_read_b64_tr_b16 v[136:137], v62 offset:24576
    ds_read_b64_tr_b16 v[138:139], v62 offset:25600
    v_mfma_f32_16x16x32_bf16 v[108:111], v[152:155], a[212:215], v[108:111]
    ds_read_b64_tr_b16 v[140:141], v63 offset:24576
    s_waitcnt lgkmcnt(5)
    v_mfma_f32_16x16x32_bf16 v[120:123], v[156:159], a[208:211], v[120:123]
    ds_read_b64_tr_b16 v[142:143], v63 offset:25600
    v_mfma_f32_16x16x32_bf16 v[124:127], v[156:159], a[212:215], v[124:127]
    s_waitcnt vmcnt(6)
    s_waitcnt lgkmcnt(4)
    v_mfma_f32_16x16x32_bf16 v[80:83], v[132:135], a[216:219], v[80:83]
    ds_read_b64_tr_b16 v[148:149], v37 offset:24576
    ds_read_b64_tr_b16 v[150:151], v37 offset:25600
    v_mfma_f32_16x16x32_bf16 v[84:87], v[132:135], a[220:223], v[84:87]
    buffer_load_dwordx4 a[248:251], v1, s[64:67], s41 offen offset:2048 sc1
    s_waitcnt lgkmcnt(4)
    v_mfma_f32_16x16x32_bf16 v[96:99], v[136:139], a[216:219], v[96:99]
    ds_read_b64_tr_b16 v[152:153], v38 offset:24576
    ds_read_b64_tr_b16 v[154:155], v38 offset:25600
    v_mfma_f32_16x16x32_bf16 v[100:103], v[136:139], a[220:223], v[100:103]
    ds_read_b64_tr_b16 v[156:157], v39 offset:24576
    s_waitcnt lgkmcnt(5)
    v_mfma_f32_16x16x32_bf16 v[112:115], v[140:143], a[216:219], v[112:115]
    ds_read_b64_tr_b16 v[158:159], v39 offset:25600
    v_mfma_f32_16x16x32_bf16 v[116:119], v[140:143], a[220:223], v[116:119]
    s_waitcnt lgkmcnt(0)
    s_barrier
    v_mfma_f32_16x16x32_bf16 v[88:91], v[148:151], a[216:219], v[88:91]
    ds_read_b64_tr_b16 v[132:133], v53 offset:0
    ds_read_b64_tr_b16 v[134:135], v53 offset:1024
    v_mfma_f32_16x16x32_bf16 v[92:95], v[148:151], a[220:223], v[92:95]
    buffer_load_dwordx4 a[252:255], v1, s[64:67], s41 offen offset:3072 sc1
    v_mfma_f32_16x16x32_bf16 v[104:107], v[152:155], a[216:219], v[104:107]
    ds_read_b64_tr_b16 v[136:137], v54 offset:0
    ds_read_b64_tr_b16 v[138:139], v54 offset:1024
    v_mfma_f32_16x16x32_bf16 v[108:111], v[152:155], a[220:223], v[108:111]
    ds_read_b64_tr_b16 v[140:141], v55 offset:0
    v_mfma_f32_16x16x32_bf16 v[120:123], v[156:159], a[216:219], v[120:123]
    ds_read_b64_tr_b16 v[142:143], v55 offset:1024
    v_mfma_f32_16x16x32_bf16 v[124:127], v[156:159], a[220:223], v[124:127]
    s_waitcnt vmcnt(6)
    s_waitcnt lgkmcnt(4)
    v_mfma_f32_16x16x32_bf16 v[80:83], v[132:135], a[224:227], v[80:83]
    ds_read_b64_tr_b16 v[148:149], v29 offset:0
    ds_read_b64_tr_b16 v[150:151], v29 offset:1024
    v_mfma_f32_16x16x32_bf16 v[84:87], v[132:135], a[228:231], v[84:87]
    s_waitcnt lgkmcnt(4)
    v_mfma_f32_16x16x32_bf16 v[96:99], v[136:139], a[224:227], v[96:99]
    ds_read_b64_tr_b16 v[152:153], v30 offset:0
    ds_read_b64_tr_b16 v[154:155], v30 offset:1024
    v_mfma_f32_16x16x32_bf16 v[100:103], v[136:139], a[228:231], v[100:103]
    ds_read_b64_tr_b16 v[156:157], v31 offset:0
    s_waitcnt lgkmcnt(5)
    v_mfma_f32_16x16x32_bf16 v[112:115], v[140:143], a[224:227], v[112:115]
    ds_read_b64_tr_b16 v[158:159], v31 offset:1024
    v_mfma_f32_16x16x32_bf16 v[116:119], v[140:143], a[228:231], v[116:119]
    s_waitcnt lgkmcnt(4)
    v_mfma_f32_16x16x32_bf16 v[88:91], v[148:151], a[224:227], v[88:91]
    ds_read_b64_tr_b16 v[132:133], v53 offset:8192
    ds_read_b64_tr_b16 v[134:135], v53 offset:9216
    v_mfma_f32_16x16x32_bf16 v[92:95], v[148:151], a[228:231], v[92:95]
    s_waitcnt lgkmcnt(4)
    v_mfma_f32_16x16x32_bf16 v[104:107], v[152:155], a[224:227], v[104:107]
    ds_read_b64_tr_b16 v[136:137], v54 offset:8192
    ds_read_b64_tr_b16 v[138:139], v54 offset:9216
    v_mfma_f32_16x16x32_bf16 v[108:111], v[152:155], a[228:231], v[108:111]
    ds_read_b64_tr_b16 v[140:141], v55 offset:8192
    s_waitcnt lgkmcnt(5)
    v_mfma_f32_16x16x32_bf16 v[120:123], v[156:159], a[224:227], v[120:123]
    ds_read_b64_tr_b16 v[142:143], v55 offset:9216
    v_mfma_f32_16x16x32_bf16 v[124:127], v[156:159], a[228:231], v[124:127]
    s_waitcnt vmcnt(4)
    s_waitcnt lgkmcnt(4)
    v_mfma_f32_16x16x32_bf16 v[80:83], v[132:135], a[232:235], v[80:83]
    ds_read_b64_tr_b16 v[148:149], v29 offset:8192
    ds_read_b64_tr_b16 v[150:151], v29 offset:9216
    v_mfma_f32_16x16x32_bf16 v[84:87], v[132:135], a[236:239], v[84:87]
    s_waitcnt lgkmcnt(4)
    v_mfma_f32_16x16x32_bf16 v[96:99], v[136:139], a[232:235], v[96:99]
    ds_read_b64_tr_b16 v[152:153], v30 offset:8192
    ds_read_b64_tr_b16 v[154:155], v30 offset:9216
    v_mfma_f32_16x16x32_bf16 v[100:103], v[136:139], a[236:239], v[100:103]
    ds_read_b64_tr_b16 v[156:157], v31 offset:8192
    s_waitcnt lgkmcnt(5)
    v_mfma_f32_16x16x32_bf16 v[112:115], v[140:143], a[232:235], v[112:115]
    ds_read_b64_tr_b16 v[158:159], v31 offset:9216
    v_mfma_f32_16x16x32_bf16 v[116:119], v[140:143], a[236:239], v[116:119]
    s_waitcnt lgkmcnt(4)
    v_mfma_f32_16x16x32_bf16 v[88:91], v[148:151], a[232:235], v[88:91]
    ds_read_b64_tr_b16 v[132:133], v53 offset:16384
    ds_read_b64_tr_b16 v[134:135], v53 offset:17408
    v_mfma_f32_16x16x32_bf16 v[92:95], v[148:151], a[236:239], v[92:95]
    s_waitcnt lgkmcnt(4)
    v_mfma_f32_16x16x32_bf16 v[104:107], v[152:155], a[232:235], v[104:107]
    ds_read_b64_tr_b16 v[136:137], v54 offset:16384
    ds_read_b64_tr_b16 v[138:139], v54 offset:17408
    v_mfma_f32_16x16x32_bf16 v[108:111], v[152:155], a[236:239], v[108:111]
    ds_read_b64_tr_b16 v[140:141], v55 offset:16384
    s_waitcnt lgkmcnt(5)
    v_mfma_f32_16x16x32_bf16 v[120:123], v[156:159], a[232:235], v[120:123]
    ds_read_b64_tr_b16 v[142:143], v55 offset:17408
    v_mfma_f32_16x16x32_bf16 v[124:127], v[156:159], a[236:239], v[124:127]
    s_waitcnt vmcnt(2)
    s_waitcnt lgkmcnt(4)
    v_mfma_f32_16x16x32_bf16 v[80:83], v[132:135], a[240:243], v[80:83]
    ds_read_b64_tr_b16 v[148:149], v29 offset:16384
    ds_read_b64_tr_b16 v[150:151], v29 offset:17408
    v_mfma_f32_16x16x32_bf16 v[84:87], v[132:135], a[244:247], v[84:87]
    s_waitcnt lgkmcnt(4)
    v_mfma_f32_16x16x32_bf16 v[96:99], v[136:139], a[240:243], v[96:99]
    ds_read_b64_tr_b16 v[152:153], v30 offset:16384
    ds_read_b64_tr_b16 v[154:155], v30 offset:17408
    v_mfma_f32_16x16x32_bf16 v[100:103], v[136:139], a[244:247], v[100:103]
    ds_read_b64_tr_b16 v[156:157], v31 offset:16384
    s_waitcnt lgkmcnt(5)
    v_mfma_f32_16x16x32_bf16 v[112:115], v[140:143], a[240:243], v[112:115]
    ds_read_b64_tr_b16 v[158:159], v31 offset:17408
    v_mfma_f32_16x16x32_bf16 v[116:119], v[140:143], a[244:247], v[116:119]
    s_waitcnt lgkmcnt(4)
    v_mfma_f32_16x16x32_bf16 v[88:91], v[148:151], a[240:243], v[88:91]
    ds_read_b64_tr_b16 v[132:133], v53 offset:24576
    ds_read_b64_tr_b16 v[134:135], v53 offset:25600
    v_mfma_f32_16x16x32_bf16 v[92:95], v[148:151], a[244:247], v[92:95]
    s_waitcnt lgkmcnt(4)
    v_mfma_f32_16x16x32_bf16 v[104:107], v[152:155], a[240:243], v[104:107]
    ds_read_b64_tr_b16 v[136:137], v54 offset:24576
    ds_read_b64_tr_b16 v[138:139], v54 offset:25600
    v_mfma_f32_16x16x32_bf16 v[108:111], v[152:155], a[244:247], v[108:111]
    ds_read_b64_tr_b16 v[140:141], v55 offset:24576
    s_waitcnt lgkmcnt(5)
    v_mfma_f32_16x16x32_bf16 v[120:123], v[156:159], a[240:243], v[120:123]
    ds_read_b64_tr_b16 v[142:143], v55 offset:25600
    v_mfma_f32_16x16x32_bf16 v[124:127], v[156:159], a[244:247], v[124:127]
    s_waitcnt vmcnt(0)
    s_waitcnt lgkmcnt(4)
    v_mfma_f32_16x16x32_bf16 v[80:83], v[132:135], a[248:251], v[80:83]
    ds_read_b64_tr_b16 v[148:149], v29 offset:24576
    ds_read_b64_tr_b16 v[150:151], v29 offset:25600
    v_mfma_f32_16x16x32_bf16 v[84:87], v[132:135], a[252:255], v[84:87]
    s_waitcnt lgkmcnt(4)
    v_mfma_f32_16x16x32_bf16 v[96:99], v[136:139], a[248:251], v[96:99]
    ds_read_b64_tr_b16 v[152:153], v30 offset:24576
    ds_read_b64_tr_b16 v[154:155], v30 offset:25600
    v_mfma_f32_16x16x32_bf16 v[100:103], v[136:139], a[252:255], v[100:103]
    ds_read_b64_tr_b16 v[156:157], v31 offset:24576
    s_waitcnt lgkmcnt(5)
    v_mfma_f32_16x16x32_bf16 v[112:115], v[140:143], a[248:251], v[112:115]
    ds_read_b64_tr_b16 v[158:159], v31 offset:25600
    v_mfma_f32_16x16x32_bf16 v[116:119], v[140:143], a[252:255], v[116:119]
    s_waitcnt lgkmcnt(4)
    v_mfma_f32_16x16x32_bf16 v[88:91], v[148:151], a[248:251], v[88:91]
    ds_read_b64_tr_b16 v[200:201], v52 offset:32768
    ds_read_b64_tr_b16 v[202:203], v52 offset:33792
    v_mfma_f32_16x16x32_bf16 v[92:95], v[148:151], a[252:255], v[92:95]
    ds_read_b64_tr_b16 v[204:205], v28 offset:32768
    s_waitcnt lgkmcnt(5)
    v_mfma_f32_16x16x32_bf16 v[104:107], v[152:155], a[248:251], v[104:107]
    ds_read_b64_tr_b16 v[206:207], v28 offset:33792
    ds_read_b64_tr_b16 v[208:209], v52 offset:40960
    v_mfma_f32_16x16x32_bf16 v[108:111], v[152:155], a[252:255], v[108:111]
    ds_read_b64_tr_b16 v[210:211], v52 offset:41984
    s_waitcnt lgkmcnt(6)
    v_mfma_f32_16x16x32_bf16 v[120:123], v[156:159], a[248:251], v[120:123]
    ds_read_b64_tr_b16 v[212:213], v28 offset:40960
    ds_read_b64_tr_b16 v[214:215], v28 offset:41984
    v_mfma_f32_16x16x32_bf16 v[124:127], v[156:159], a[252:255], v[124:127]
    s_waitcnt lgkmcnt(6)
    v_mfma_f32_16x16x32_bf16 v[64:67], v[200:203], a[96:99], v[64:67]
    ds_read_b64_tr_b16 v[216:217], v52 offset:49152
    ds_read_b64_tr_b16 v[218:219], v52 offset:50176
    v_mfma_f32_16x16x32_bf16 v[68:71], v[200:203], a[100:103], v[68:71]
    s_nop 3
    s_xor_b32 s39, s33, 1
    s_and_b32 s39, s39, 3
    s_mul_i32 s39, s39, 6144
    s_add_u32 s39, s39, 0
    s_add_u32 s39, s39, s3
    v_cvt_pk_bf16_f32 v168, v80, v81
    v_cvt_pk_bf16_f32 v169, v82, v83
    v_cvt_pk_bf16_f32 v170, v84, v85
    v_cvt_pk_bf16_f32 v171, v86, v87
    buffer_store_dwordx4 v[168:171], v1, s[64:67], s39 offen offset:0 sc1
    s_waitcnt lgkmcnt(6)
    v_mfma_f32_16x16x32_bf16 v[72:75], v[204:207], a[96:99], v[72:75]
    ds_read_b64_tr_b16 v[220:221], v28 offset:49152
    ds_read_b64_tr_b16 v[222:223], v28 offset:50176
    v_mfma_f32_16x16x32_bf16 v[76:79], v[204:207], a[100:103], v[76:79]
    v_cvt_pk_bf16_f32 v172, v88, v89
    v_cvt_pk_bf16_f32 v173, v90, v91
    v_cvt_pk_bf16_f32 v174, v92, v93
    v_cvt_pk_bf16_f32 v175, v94, v95
    buffer_store_dwordx4 v[172:175], v1, s[64:67], s39 offen offset:1024 sc1
    s_waitcnt lgkmcnt(6)
    v_mfma_f32_16x16x32_bf16 v[64:67], v[208:211], a[104:107], v[64:67]
    ds_read_b64_tr_b16 v[224:225], v52 offset:57344
    ds_read_b64_tr_b16 v[226:227], v52 offset:58368
    v_mfma_f32_16x16x32_bf16 v[68:71], v[208:211], a[108:111], v[68:71]
    s_xor_b32 s39, s33, 2
    s_and_b32 s39, s39, 3
    s_mul_i32 s39, s39, 6144
    s_add_u32 s39, s39, 2048
    s_add_u32 s39, s39, s3
    v_cvt_pk_bf16_f32 v176, v96, v97
    v_cvt_pk_bf16_f32 v177, v98, v99
    v_cvt_pk_bf16_f32 v178, v100, v101
    v_cvt_pk_bf16_f32 v179, v102, v103
    buffer_store_dwordx4 v[176:179], v1, s[64:67], s39 offen offset:0 sc1
    s_waitcnt lgkmcnt(6)
    v_mfma_f32_16x16x32_bf16 v[72:75], v[212:215], a[104:107], v[72:75]
    ds_read_b64_tr_b16 v[228:229], v28 offset:57344
    ds_read_b64_tr_b16 v[230:231], v28 offset:58368
    v_mfma_f32_16x16x32_bf16 v[76:79], v[212:215], a[108:111], v[76:79]
    v_cvt_pk_bf16_f32 v180, v104, v105
    v_cvt_pk_bf16_f32 v181, v106, v107
    v_cvt_pk_bf16_f32 v182, v108, v109
    v_cvt_pk_bf16_f32 v183, v110, v111
    buffer_store_dwordx4 v[180:183], v1, s[64:67], s39 offen offset:1024 sc1
    s_waitcnt lgkmcnt(6)
    v_mfma_f32_16x16x32_bf16 v[64:67], v[216:219], a[112:115], v[64:67]
    ds_read_b64_tr_b16 v[200:201], v56 offset:0
    ds_read_b64_tr_b16 v[202:203], v56 offset:1024
    v_mfma_f32_16x16x32_bf16 v[68:71], v[216:219], a[116:119], v[68:71]
    s_xor_b32 s39, s33, 3
    s_and_b32 s39, s39, 3
    s_mul_i32 s39, s39, 6144
    s_add_u32 s39, s39, 4096
    s_add_u32 s39, s39, s3
    v_cvt_pk_bf16_f32 v184, v112, v113
    v_cvt_pk_bf16_f32 v185, v114, v115
    v_cvt_pk_bf16_f32 v186, v116, v117
    v_cvt_pk_bf16_f32 v187, v118, v119
    buffer_store_dwordx4 v[184:187], v1, s[64:67], s39 offen offset:0 sc1
    s_waitcnt lgkmcnt(6)
    v_mfma_f32_16x16x32_bf16 v[72:75], v[220:223], a[112:115], v[72:75]
    ds_read_b64_tr_b16 v[204:205], v32 offset:0
    ds_read_b64_tr_b16 v[206:207], v32 offset:1024
    v_mfma_f32_16x16x32_bf16 v[76:79], v[220:223], a[116:119], v[76:79]
    v_cvt_pk_bf16_f32 v188, v120, v121
    v_cvt_pk_bf16_f32 v189, v122, v123
    v_cvt_pk_bf16_f32 v190, v124, v125
    v_cvt_pk_bf16_f32 v191, v126, v127
    buffer_store_dwordx4 v[188:191], v1, s[64:67], s39 offen offset:1024 sc1
    s_waitcnt lgkmcnt(6)
    v_mfma_f32_16x16x32_bf16 v[64:67], v[224:227], a[120:123], v[64:67]
    ds_read_b64_tr_b16 v[208:209], v56 offset:8192
    ds_read_b64_tr_b16 v[210:211], v56 offset:9216
    v_mfma_f32_16x16x32_bf16 v[68:71], v[224:227], a[124:127], v[68:71]
    v_and_b32 v4, 31, v0
    v_lshrrev_b32 v3, 5, v0
    v_lshlrev_b32 v3, 4, v3
    v_lshl_add_u32 v4, v4, 12, v3
    s_lshl_b32 s43, s38, 17
    s_lshl_b32 s39, s32, 11
    s_add_u32 s43, s43, s39
    s_lshl_b32 s39, s35, 8
    s_add_u32 s43, s43, s39
    s_lshl_b32 s39, s33, 6
    s_add_u32 s43, s43, s39
    s_mov_b32 s42, 0xffff0000
    s_mov_b32 s8, 0
    s_waitcnt lgkmcnt(6)
    v_mfma_f32_16x16x32_bf16 v[72:75], v[228:231], a[120:123], v[72:75]
    ds_read_b64_tr_b16 v[212:213], v32 offset:8192
    ds_read_b64_tr_b16 v[214:215], v32 offset:9216
    v_mfma_f32_16x16x32_bf16 v[76:79], v[228:231], a[124:127], v[76:79]
    s_waitcnt lgkmcnt(6)
    v_mfma_f32_16x16x32_bf16 v[64:67], v[200:203], a[128:131], v[64:67]
    ds_read_b64_tr_b16 v[216:217], v56 offset:16384
    ds_read_b64_tr_b16 v[218:219], v56 offset:17408
    v_mfma_f32_16x16x32_bf16 v[68:71], v[200:203], a[132:135], v[68:71]
    s_waitcnt lgkmcnt(6)
    v_mfma_f32_16x16x32_bf16 v[72:75], v[204:207], a[128:131], v[72:75]
    ds_read_b64_tr_b16 v[220:221], v32 offset:16384
    ds_read_b64_tr_b16 v[222:223], v32 offset:17408
    v_mfma_f32_16x16x32_bf16 v[76:79], v[204:207], a[132:135], v[76:79]
    s_waitcnt lgkmcnt(6)
    v_mfma_f32_16x16x32_bf16 v[64:67], v[208:211], a[136:139], v[64:67]
    ds_read_b64_tr_b16 v[224:225], v56 offset:24576
    ds_read_b64_tr_b16 v[226:227], v56 offset:25600
    v_mfma_f32_16x16x32_bf16 v[68:71], v[208:211], a[140:143], v[68:71]
    s_waitcnt lgkmcnt(6)
    v_mfma_f32_16x16x32_bf16 v[72:75], v[212:215], a[136:139], v[72:75]
    ds_read_b64_tr_b16 v[228:229], v32 offset:24576
    ds_read_b64_tr_b16 v[230:231], v32 offset:25600
    v_mfma_f32_16x16x32_bf16 v[76:79], v[212:215], a[140:143], v[76:79]
    s_waitcnt lgkmcnt(6)
    v_mfma_f32_16x16x32_bf16 v[64:67], v[216:219], a[144:147], v[64:67]
    ds_read_b64_tr_b16 v[200:201], v56 offset:32768
    ds_read_b64_tr_b16 v[202:203], v56 offset:33792
    v_mfma_f32_16x16x32_bf16 v[68:71], v[216:219], a[148:151], v[68:71]
    s_waitcnt lgkmcnt(6)
    v_mfma_f32_16x16x32_bf16 v[72:75], v[220:223], a[144:147], v[72:75]
    ds_read_b64_tr_b16 v[204:205], v32 offset:32768
    ds_read_b64_tr_b16 v[206:207], v32 offset:33792
    v_mfma_f32_16x16x32_bf16 v[76:79], v[220:223], a[148:151], v[76:79]
    s_waitcnt lgkmcnt(6)
    v_mfma_f32_16x16x32_bf16 v[64:67], v[224:227], a[152:155], v[64:67]
    ds_read_b64_tr_b16 v[208:209], v56 offset:40960
    ds_read_b64_tr_b16 v[210:211], v56 offset:41984
    v_mfma_f32_16x16x32_bf16 v[68:71], v[224:227], a[156:159], v[68:71]
    s_waitcnt lgkmcnt(6)
    v_mfma_f32_16x16x32_bf16 v[72:75], v[228:231], a[152:155], v[72:75]
    ds_read_b64_tr_b16 v[212:213], v32 offset:40960
    ds_read_b64_tr_b16 v[214:215], v32 offset:41984
    v_mfma_f32_16x16x32_bf16 v[76:79], v[228:231], a[156:159], v[76:79]
    s_waitcnt lgkmcnt(6)
    v_mfma_f32_16x16x32_bf16 v[64:67], v[200:203], a[160:163], v[64:67]
    ds_read_b64_tr_b16 v[216:217], v56 offset:49152
    ds_read_b64_tr_b16 v[218:219], v56 offset:50176
    v_mfma_f32_16x16x32_bf16 v[68:71], v[200:203], a[164:167], v[68:71]
    s_waitcnt lgkmcnt(6)
    v_mfma_f32_16x16x32_bf16 v[72:75], v[204:207], a[160:163], v[72:75]
    ds_read_b64_tr_b16 v[220:221], v32 offset:49152
    ds_read_b64_tr_b16 v[222:223], v32 offset:50176
    v_mfma_f32_16x16x32_bf16 v[76:79], v[204:207], a[164:167], v[76:79]
    s_waitcnt lgkmcnt(6)
    v_mfma_f32_16x16x32_bf16 v[64:67], v[208:211], a[168:171], v[64:67]
    ds_read_b64_tr_b16 v[224:225], v56 offset:57344
    ds_read_b64_tr_b16 v[226:227], v56 offset:58368
    v_mfma_f32_16x16x32_bf16 v[68:71], v[208:211], a[172:175], v[68:71]
    s_waitcnt lgkmcnt(6)
    v_mfma_f32_16x16x32_bf16 v[72:75], v[212:215], a[168:171], v[72:75]
    ds_read_b64_tr_b16 v[228:229], v32 offset:57344
    ds_read_b64_tr_b16 v[230:231], v32 offset:58368
    v_mfma_f32_16x16x32_bf16 v[76:79], v[212:215], a[172:175], v[76:79]
    s_waitcnt lgkmcnt(6)
    v_mfma_f32_16x16x32_bf16 v[64:67], v[216:219], a[176:179], v[64:67]
    ds_read_b64_tr_b16 v[200:201], v60 offset:0
    ds_read_b64_tr_b16 v[202:203], v60 offset:1024
    v_mfma_f32_16x16x32_bf16 v[68:71], v[216:219], a[180:183], v[68:71]
    s_waitcnt lgkmcnt(6)
    v_mfma_f32_16x16x32_bf16 v[72:75], v[220:223], a[176:179], v[72:75]
    ds_read_b64_tr_b16 v[204:205], v36 offset:0
    ds_read_b64_tr_b16 v[206:207], v36 offset:1024
    v_mfma_f32_16x16x32_bf16 v[76:79], v[220:223], a[180:183], v[76:79]
    s_waitcnt lgkmcnt(6)
    v_mfma_f32_16x16x32_bf16 v[64:67], v[224:227], a[184:187], v[64:67]
    ds_read_b64_tr_b16 v[208:209], v60 offset:8192
    ds_read_b64_tr_b16 v[210:211], v60 offset:9216
    v_mfma_f32_16x16x32_bf16 v[68:71], v[224:227], a[188:191], v[68:71]
    s_waitcnt lgkmcnt(6)
    v_mfma_f32_16x16x32_bf16 v[72:75], v[228:231], a[184:187], v[72:75]
    ds_read_b64_tr_b16 v[212:213], v36 offset:8192
    ds_read_b64_tr_b16 v[214:215], v36 offset:9216
    v_mfma_f32_16x16x32_bf16 v[76:79], v[228:231], a[188:191], v[76:79]
    s_waitcnt lgkmcnt(6)
    v_mfma_f32_16x16x32_bf16 v[64:67], v[200:203], a[192:195], v[64:67]
    ds_read_b64_tr_b16 v[216:217], v60 offset:16384
    ds_read_b64_tr_b16 v[218:219], v60 offset:17408
    v_mfma_f32_16x16x32_bf16 v[68:71], v[200:203], a[196:199], v[68:71]
    s_waitcnt lgkmcnt(6)
    v_mfma_f32_16x16x32_bf16 v[72:75], v[204:207], a[192:195], v[72:75]
    ds_read_b64_tr_b16 v[220:221], v36 offset:16384
    ds_read_b64_tr_b16 v[222:223], v36 offset:17408
    v_mfma_f32_16x16x32_bf16 v[76:79], v[204:207], a[196:199], v[76:79]
    s_waitcnt lgkmcnt(6)
    v_mfma_f32_16x16x32_bf16 v[64:67], v[208:211], a[200:203], v[64:67]
    ds_read_b64_tr_b16 v[224:225], v60 offset:24576
    ds_read_b64_tr_b16 v[226:227], v60 offset:25600
    v_mfma_f32_16x16x32_bf16 v[68:71], v[208:211], a[204:207], v[68:71]
    s_waitcnt lgkmcnt(6)
    v_mfma_f32_16x16x32_bf16 v[72:75], v[212:215], a[200:203], v[72:75]
    ds_read_b64_tr_b16 v[228:229], v36 offset:24576
    ds_read_b64_tr_b16 v[230:231], v36 offset:25600
    v_mfma_f32_16x16x32_bf16 v[76:79], v[212:215], a[204:207], v[76:79]
    s_waitcnt lgkmcnt(6)
    v_mfma_f32_16x16x32_bf16 v[64:67], v[216:219], a[208:211], v[64:67]
    ds_read_b64_tr_b16 v[200:201], v52 offset:0
    ds_read_b64_tr_b16 v[202:203], v52 offset:1024
    v_mfma_f32_16x16x32_bf16 v[68:71], v[216:219], a[212:215], v[68:71]
    s_waitcnt lgkmcnt(6)
    v_mfma_f32_16x16x32_bf16 v[72:75], v[220:223], a[208:211], v[72:75]
    ds_read_b64_tr_b16 v[204:205], v28 offset:0
    ds_read_b64_tr_b16 v[206:207], v28 offset:1024
    v_mfma_f32_16x16x32_bf16 v[76:79], v[220:223], a[212:215], v[76:79]
    s_waitcnt lgkmcnt(6)
    v_mfma_f32_16x16x32_bf16 v[64:67], v[224:227], a[216:219], v[64:67]
    ds_read_b64_tr_b16 v[208:209], v52 offset:8192
    ds_read_b64_tr_b16 v[210:211], v52 offset:9216
    v_mfma_f32_16x16x32_bf16 v[68:71], v[224:227], a[220:223], v[68:71]
    buffer_load_dwordx4 v[128:131], v1, s[64:67], s4 offen offset:0 sc1
    s_waitcnt lgkmcnt(6)
    v_mfma_f32_16x16x32_bf16 v[72:75], v[228:231], a[216:219], v[72:75]
    ds_read_b64_tr_b16 v[212:213], v28 offset:8192
    ds_read_b64_tr_b16 v[214:215], v28 offset:9216
    v_mfma_f32_16x16x32_bf16 v[76:79], v[228:231], a[220:223], v[76:79]
    buffer_load_dwordx4 v[132:135], v1, s[64:67], s4 offen offset:1024 sc1
    s_waitcnt lgkmcnt(6)
    v_mfma_f32_16x16x32_bf16 v[64:67], v[200:203], a[224:227], v[64:67]
    ds_read_b64_tr_b16 v[216:217], v52 offset:16384
    ds_read_b64_tr_b16 v[218:219], v52 offset:17408
    v_mfma_f32_16x16x32_bf16 v[68:71], v[200:203], a[228:231], v[68:71]
    buffer_load_dwordx4 v[136:139], v1, s[64:67], s4 offen offset:2048 sc1
    s_waitcnt lgkmcnt(6)
    v_mfma_f32_16x16x32_bf16 v[72:75], v[204:207], a[224:227], v[72:75]
    ds_read_b64_tr_b16 v[220:221], v28 offset:16384
    ds_read_b64_tr_b16 v[222:223], v28 offset:17408
    v_mfma_f32_16x16x32_bf16 v[76:79], v[204:207], a[228:231], v[76:79]
    buffer_load_dwordx4 v[140:143], v1, s[64:67], s4 offen offset:3072 sc1
    s_waitcnt lgkmcnt(6)
    v_mfma_f32_16x16x32_bf16 v[64:67], v[208:211], a[232:235], v[64:67]
    ds_read_b64_tr_b16 v[224:225], v52 offset:24576
    ds_read_b64_tr_b16 v[226:227], v52 offset:25600
    v_mfma_f32_16x16x32_bf16 v[68:71], v[208:211], a[236:239], v[68:71]
    buffer_load_dwordx4 v[144:147], v1, s[64:67], s5 offen offset:0 sc1
    s_waitcnt lgkmcnt(6)
    v_mfma_f32_16x16x32_bf16 v[72:75], v[212:215], a[232:235], v[72:75]
    ds_read_b64_tr_b16 v[228:229], v28 offset:24576
    ds_read_b64_tr_b16 v[230:231], v28 offset:25600
    v_mfma_f32_16x16x32_bf16 v[76:79], v[212:215], a[236:239], v[76:79]
    buffer_load_dwordx4 v[148:151], v1, s[64:67], s5 offen offset:1024 sc1
    s_waitcnt lgkmcnt(6)
    v_mfma_f32_16x16x32_bf16 v[64:67], v[216:219], a[240:243], v[64:67]
    v_mfma_f32_16x16x32_bf16 v[68:71], v[216:219], a[244:247], v[68:71]
    s_waitcnt lgkmcnt(4)
    v_mfma_f32_16x16x32_bf16 v[72:75], v[220:223], a[240:243], v[72:75]
    v_mfma_f32_16x16x32_bf16 v[76:79], v[220:223], a[244:247], v[76:79]
    s_waitcnt lgkmcnt(2)
    v_mfma_f32_16x16x32_bf16 v[64:67], v[224:227], a[248:251], v[64:67]
    v_mfma_f32_16x16x32_bf16 v[68:71], v[224:227], a[252:255], v[68:71]
    s_waitcnt lgkmcnt(0)
    v_mfma_f32_16x16x32_bf16 v[72:75], v[228:231], a[248:251], v[72:75]
    v_mfma_f32_16x16x32_bf16 v[76:79], v[228:231], a[252:255], v[76:79]
    s_branch L_pchk
L_ppoll:
    buffer_load_dwordx4 v[128:131], v1, s[64:67], s4 offen offset:0 sc1
    buffer_load_dwordx4 v[132:135], v1, s[64:67], s4 offen offset:1024 sc1
    buffer_load_dwordx4 v[136:139], v1, s[64:67], s4 offen offset:2048 sc1
    buffer_load_dwordx4 v[140:143], v1, s[64:67], s4 offen offset:3072 sc1
    buffer_load_dwordx4 v[144:147], v1, s[64:67], s5 offen offset:0 sc1
    buffer_load_dwordx4 v[148:151], v1, s[64:67], s5 offen offset:1024 sc1
L_pchk:
    s_add_u32 s8, s8, 1
    s_cmp_gt_u32 s8, 0x100000
    s_waitcnt vmcnt(0)
    s_cbranch_scc1 L_pok
    v_max3_u32 v5, v128, v129, v130
    v_max3_u32 v6, v131, v132, v133
    v_max3_u32 v5, v5, v134, v135
    v_max3_u32 v6, v6, v136, v137
    v_max3_u32 v5, v5, v138, v139
    v_max3_u32 v6, v6, v140, v141
    v_max3_u32 v5, v5, v142, v143
    v_max3_u32 v6, v6, v144, v145
    v_max3_u32 v5, v5, v146, v147
    v_max3_u32 v6, v6, v148, v149
    v_max3_u32 v5, v5, v150, v151
    v_max_u32 v5, v5, v6
    v_cmp_eq_u32 vcc, -1, v5
    s_cbranch_vccnz L_ppoll
L_pok:
    v_lshlrev_b32 v232, 16, v128
    v_and_b32 v233, s42, v128
    v_lshlrev_b32 v234, 16, v136
    v_and_b32 v235, s42, v136
    v_lshlrev_b32 v236, 16, v144
    v_and_b32 v237, s42, v144
    v_pk_add_f32 v[232:233], v[232:233], v[234:235]
    v_pk_add_f32 v[64:65], v[64:65], v[236:237]
    v_pk_add_f32 v[64:65], v[64:65], v[232:233]
    v_cvt_pk_bf16_f32 v248, v64, v65
    v_lshlrev_b32 v232, 16, v129
    v_and_b32 v233, s42, v129
    v_lshlrev_b32 v234, 16, v137
    v_and_b32 v235, s42, v137
    v_lshlrev_b32 v236, 16, v145
    v_and_b32 v237, s42, v145
    v_pk_add_f32 v[232:233], v[232:233], v[234:235]
    v_pk_add_f32 v[66:67], v[66:67], v[236:237]
    v_pk_add_f32 v[66:67], v[66:67], v[232:233]
    v_cvt_pk_bf16_f32 v249, v66, v67
    v_lshlrev_b32 v232, 16, v130
    v_and_b32 v233, s42, v130
    v_lshlrev_b32 v234, 16, v138
    v_and_b32 v235, s42, v138
    v_lshlrev_b32 v236, 16, v146
    v_and_b32 v237, s42, v146
    v_pk_add_f32 v[232:233], v[232:233], v[234:235]
    v_pk_add_f32 v[68:69], v[68:69], v[236:237]
    v_pk_add_f32 v[68:69], v[68:69], v[232:233]
    v_cvt_pk_bf16_f32 v250, v68, v69
    v_lshlrev_b32 v232, 16, v131
    v_and_b32 v233, s42, v131
    v_lshlrev_b32 v234, 16, v139
    v_and_b32 v235, s42, v139
    v_lshlrev_b32 v236, 16, v147
    v_and_b32 v237, s42, v147
    v_pk_add_f32 v[232:233], v[232:233], v[234:235]
    v_pk_add_f32 v[70:71], v[70:71], v[236:237]
    v_pk_add_f32 v[70:71], v[70:71], v[232:233]
    v_cvt_pk_bf16_f32 v251, v70, v71
    s_nop 1
    v_permlane16_swap_b32 v248, v250
    v_permlane16_swap_b32 v249, v251
    buffer_store_dwordx4 v[248:251], v4, s[20:23], s43 offen offset:0
    v_lshlrev_b32 v232, 16, v132
    v_and_b32 v233, s42, v132
    v_lshlrev_b32 v234, 16, v140
    v_and_b32 v235, s42, v140
    v_lshlrev_b32 v236, 16, v148
    v_and_b32 v237, s42, v148
    v_pk_add_f32 v[232:233], v[232:233], v[234:235]
    v_pk_add_f32 v[72:73], v[72:73], v[236:237]
    v_pk_add_f32 v[72:73], v[72:73], v[232:233]
    v_cvt_pk_bf16_f32 v252, v72, v73
    v_lshlrev_b32 v232, 16, v133
    v_and_b32 v233, s42, v133
    v_lshlrev_b32 v234, 16, v141
    v_and_b32 v235, s42, v141
    v_lshlrev_b32 v236, 16, v149
    v_and_b32 v237, s42, v149
    v_pk_add_f32 v[232:233], v[232:233], v[234:235]
    v_pk_add_f32 v[74:75], v[74:75], v[236:237]
    v_pk_add_f32 v[74:75], v[74:75], v[232:233]
    v_cvt_pk_bf16_f32 v253, v74, v75
    v_lshlrev_b32 v232, 16, v134
    v_and_b32 v233, s42, v134
    v_lshlrev_b32 v234, 16, v142
    v_and_b32 v235, s42, v142
    v_lshlrev_b32 v236, 16, v150
    v_and_b32 v237, s42, v150
    v_pk_add_f32 v[232:233], v[232:233], v[234:235]
    v_pk_add_f32 v[76:77], v[76:77], v[236:237]
    v_pk_add_f32 v[76:77], v[76:77], v[232:233]
    v_cvt_pk_bf16_f32 v254, v76, v77
    v_lshlrev_b32 v232, 16, v135
    v_and_b32 v233, s42, v135
    v_lshlrev_b32 v234, 16, v143
    v_and_b32 v235, s42, v143
    v_lshlrev_b32 v236, 16, v151
    v_and_b32 v237, s42, v151
    v_pk_add_f32 v[232:233], v[232:233], v[234:235]
    v_pk_add_f32 v[78:79], v[78:79], v[236:237]
    v_pk_add_f32 v[78:79], v[78:79], v[232:233]
    v_cvt_pk_bf16_f32 v255, v78, v79
    s_nop 1
    v_permlane16_swap_b32 v252, v254
    v_permlane16_swap_b32 v253, v255
    buffer_store_dwordx4 v[252:255], v4, s[20:23], s43 offen offset:32
L_end:
    s_endpgm
.section .rodata,"a"
.p2align 6
.amdhsa_kernel concat_heads__gqa_block_cached__mha_block_cached__near_ridge_kernel
  .amdhsa_next_free_vgpr 512
  .amdhsa_next_free_sgpr 102
  .amdhsa_accum_offset 256
  .amdhsa_group_segment_fixed_size 0
  .amdhsa_kernarg_size 104
  .amdhsa_user_sgpr_count 2
  .amdhsa_user_sgpr_kernarg_segment_ptr 1
  .amdhsa_system_sgpr_workgroup_id_x 1
.end_amdhsa_kernel
```
